```python
import torch

def _softmax(x, axis=-1):
    return torch.softmax(x, dim=axis)

def _gelu(x):
    return torch.nn.functional.gelu(x, approximate='tanh')

def _silu(x):
    return torch.nn.functional.silu(x)

def _sigmoid(x):
    return torch.sigmoid(x)

def _layernorm(x, axis=-1, eps=1e-05):
    m = x.mean(dim=axis, keepdim=True)
    v = x.var(dim=axis, keepdim=True, unbiased=False)
    return (x - m) / torch.sqrt(v + eps)

def _scatter_add(tgt, idx, src, axis=0):
    return tgt.clone().index_add_(axis, idx, src)

def _segment_sum(src, seg, n):
    out = torch.zeros((n,) + src.shape[1:], dtype=src.dtype)
    return out.index_add_(0, seg, src)

def _pad(x, pw):
    flat = tuple((v for pair in reversed(pw) for v in pair))
    return torch.nn.functional.pad(x, flat)
kernel_name = 'standalone__conformer_family_branchformer__speech'

def setup_inputs():

    _w = lambda a: (lambda t: t.to(torch.bfloat16) if t.is_floating_point() else t)(torch.as_tensor(a))
    B, T, D, K = (2, 4000, 144, 3)
    s = float(D) ** (-0.5)
    return {'x': _w((lambda *s: torch.randn(*s, dtype=torch.bfloat16) * 0.05)(B, T, D)), 'w_q': _w((lambda *s: torch.randn(*s, dtype=torch.bfloat16) * 1.6)(D, D) * s), 'w_k': _w((lambda *s: torch.randn(*s, dtype=torch.bfloat16) * 1.6)(D, D) * s), 'w_v': _w((lambda *s: torch.randn(*s, dtype=torch.bfloat16) * 0.4)(D, D) * s), 'w_ao': _w((lambda *s: torch.randn(*s, dtype=torch.bfloat16) * 0.4)(D, D) * s), 'w_up': _w((lambda *s: torch.randn(*s, dtype=torch.bfloat16) * 0.8)(D, 2 * D) * s), 'dw': _w((lambda *s: torch.randn(*s, dtype=torch.bfloat16) * 0.8)(K, D) * (1.0 / K)), 'w_dn': _w((lambda *s: torch.randn(*s, dtype=torch.bfloat16) * 0.4)(D, D) * s), 'w_merge': _w((lambda *s: torch.randn(*s, dtype=torch.bfloat16) * 0.4)(2 * D, D) * s)}

def reference(x, w_q, w_k, w_v, w_ao, w_up, dw, w_dn, w_merge):
    B, T, D = x.shape
    K = dw.shape[0]
    xa = _layernorm(x, axis=-1)
    q = torch.einsum('btd,de->bte', xa, w_q)
    k = torch.einsum('btd,de->bte', xa, w_k)
    v = torch.einsum('btd,de->bte', xa, w_v)
    logits = torch.einsum('btd,bsd->bts', q, k) * float(D) ** (-0.5)
    attn = _softmax(logits, axis=-1)
    ya = torch.einsum('bts,bsd->btd', attn, v)
    ya = torch.einsum('btd,de->bte', ya, w_ao)
    xc = _layernorm(x, axis=-1)
    h = _gelu(torch.einsum('btd,de->bte', xc, w_up))
    u = h[..., :D].clone()
    g = _layernorm(h[..., D:], axis=-1)
    pad = K // 2
    gp = _pad(g, ((0, 0), (pad, pad), (0, 0)))
    conv = torch.zeros_like(g)
    for i in range(K):
        conv = conv + gp[:, i:i + T, :] * dw[i][None, None, :]
    yc = torch.einsum('btd,de->bte', u * conv, w_dn)
    merged = torch.concatenate([ya, yc], axis=-1)
    out = torch.einsum('btf,fd->btd', merged, w_merge)
    return x + out
```

```asm
; @launch grid=(256,1,1) block=(256,1,1) lds=163840
.amdgcn_target "amdgcn-amd-amdhsa--gfx950"
.text
.globl standalone__conformer_family_branchformer__speech_kernel
.p2align 12
.p2align 8
.type standalone__conformer_family_branchformer__speech_kernel,@function
standalone__conformer_family_branchformer__speech_kernel:
    s_load_dwordx16 s[56:71], s[0:1], 0
    s_load_dwordx8 s[72:79], s[0:1], 64
    s_getpc_b64 s[24:25]
L_pf:
    s_mov_b32 s26, L_mf6-L_pf
    s_mov_b32 s27, 0x20000
    v_lshlrev_b32 v2, 4, v0
    buffer_load_dwordx4 v[252:255], v2, s[24:27], 0 offen
    s_lshl_b32 s3, s2, 9
    s_and_b32 s3, s3, 61440
    buffer_load_dwordx4 v[252:255], v2, s[24:27], s3 offen
    v_lshrrev_b32 v1, 6, v0
    s_bfe_u32 s6, s2, 0x10003
    v_readfirstlane_b32 s40, v1
    s_memrealtime s[4:5]
    s_and_b32 s7, s2, 7
    s_lshl1_add_u32 s7, s7, s6
    s_mov_b32 s6, s2
    s_andn2_b32 s2, s2, 15
    s_or_b32 s2, s2, s7
    s_cmp_ge_u32 s2, 252
    s_cbranch_scc1 L_wfuse
    v_and_b32 v0, 63, v0
    s_bfe_u32 s41, s2, 0x10001
    s_lshr_b32 s43, s2, 2
    s_lshr_b32 s52, s40, 1
    s_xor_b32 s52, s52, s2
    s_andn2_b32 s52, 1, s52
    s_lshl1_add_u32 s55, s43, s52
    s_mul_i32 s52, s41, 125
    s_add_u32 s53, s55, s52
    s_and_b32 s54, s40, 1
    s_lshl1_add_u32 s54, s53, s54
    v_lshlrev_b32_e64 v6, 4, v0
    s_mul_i32 s53, s54, 4608
    s_mul_i32 s47, s40, 4608
    s_add_u32 m0, s47, 92160
    s_mov_b32 s10, 2304000
    s_mov_b32 s11, s27
    s_add_u32 s45, s53, 4096
    s_waitcnt lgkmcnt(0)
    s_mov_b64 s[8:9], s[56:57]
    s_nop 0
    buffer_load_dwordx4 v6, s[8:11], s53 offen offset:0 lds
    buffer_load_dwordx4 v6, s[8:11], s53 offen offset:1024 lds
    buffer_load_dwordx4 v6, s[8:11], s53 offen offset:2048 lds
    buffer_load_dwordx4 v6, s[8:11], s53 offen offset:3072 lds
    s_add_u32 m0, s47, 96256
    s_mov_b32 exec_hi, 0
    buffer_load_dwordx4 v6, s[8:11], s45 offen lds
    s_mov_b32 exec_hi, -1
    s_add_u32 s47, s47, 92160
    s_and_b32 s42, s2, 1
    s_lshl1_add_u32 s48, s43, s42
    s_cmp_lt_u32 s48, 125
    s_cselect_b32 s50, 1, 0
    s_add_u32 s48, s48, s52
    s_mov_b32 s16, s66
    s_mov_b32 s17, s67
    s_mov_b32 s18, 82944
    s_mov_b32 s19, 0x20000
    s_mov_b32 s28, s58
    s_mov_b32 s29, s59
    s_mov_b32 s30, 41472
    s_mov_b32 s31, 0x20000
    s_mov_b32 s24, s60
    s_mov_b32 s25, s61
    s_mov_b32 s26, 41472
    s_mov_b32 s27, 0x20000
    s_lshr_b32 s52, s6, 3
    s_lshl_b32 s52, s52, 12
    s_lshl_b32 s70, s40, 10
    s_add_u32 s52, s52, s70
    buffer_load_dwordx4 v[252:255], v6, s[28:31], s52 offen
    s_add_u32 s53, s52, 89088
    s_and_b32 s53, s53, 130048
    buffer_load_dwordx4 v[252:255], v6, s[24:27], s53 offen
    s_add_u32 s53, s52, 89088
    s_and_b32 s53, s53, 130048
    buffer_load_dwordx4 v[252:255], v6, s[16:19], s53 offen
    s_mov_b32 s32, s74
    s_mov_b32 s33, s75
    s_mov_b32 s34, 2304000
    s_mov_b32 s35, 0x20000
    s_mov_b32 s20, s76
    s_mov_b32 s21, s77
    s_mov_b32 s22, 256
    s_mov_b32 s23, 0x20000
    s_bfe_u32 s75, s4, 393227
    s_mul_i32 s75, s75, 2621440
    s_add_u32 s75, s75, 12582912
    s_mov_b32 s12, s78
    s_mov_b32 s13, s79
    s_mov_b32 s14, 268435456
    s_mov_b32 s15, 0x20000
    s_bfe_u32 s52, s6, 0x40003
    s_sub_u32 s53, s52, 9
    s_cselect_b32 s52, s52, s53
    v_mov_b32 v249, 0
    s_lshl_b32 s53, s52, 21
    s_cmp_lt_u32 s52, 6
    s_cbranch_scc0 L_tl1
    s_sub_u32 s56, s75, 8388608
    s_cmp_lt_u32 s52, 4
    s_cselect_b32 s56, 2097152, s56
    s_add_u32 s53, s53, s56
    buffer_load_dword v252, v249, s[12:15], s53 offen
    s_branch L_tl3
    L_tl1:
    s_cmp_eq_u32 s52, 7
    s_cbranch_scc1 L_tl2
    s_and_b32 s52, s52, 8
    s_lshl_b32 s52, s52, 18
    buffer_load_dword v252, v249, s[32:35], s52 offen
    s_branch L_tl3
    L_tl2:
    s_or_b32 s4, s4, 1
    v_lshlrev_b32 v249, 8, v0
    v_mov_b32 v250, s4
    s_lshl2_add_u32 s5, s6, s40
    s_cmp_eq_u32 s5, 224
    s_cbranch_scc0 L_tl4
    buffer_store_dword v250, v249, s[20:23], 0 offen sc1
    s_branch L_tl3
    L_tl4:
    buffer_load_dword v252, v249, s[20:23], 0 offen offset:128
    L_tl3:
    s_cmp_lt_u32 s55, 125
    s_cselect_b32 s72, 1, 0
    s_mov_b32 s73, s54
    s_mul_i32 s71, s42, 288
    s_cmp_eq_u32 s40, 0
    s_cselect_b32 s69, 0, 123904
    s_lshl_b32 s52, s40, 6
    v_add_u32 v250, s52, v0
    v_lshlrev_b32 v251, 4, v250
    s_mov_b32 s52, 288
    v_mul_u32_u24 v193, 29128, v250
    v_add_u32 v194, 116512, v193
    v_add_u32 v195, 233024, v193
    v_add_u32 v196, 349536, v193
    v_add_u32 v197, 466048, v193
    v_add_u32 v198, 58256, v193
    v_add_u32 v199, 174768, v193
    v_add_u32 v104, 291280, v193
    v_add_u32 v105, 407792, v193
    v_add_u32_e64 v106, 0, v193
    v_add_u32 v107, 116512, v193
    v_lshrrev_b32 v193, 19, v193
    v_lshrrev_b32 v194, 19, v194
    v_lshrrev_b32 v195, 19, v195
    v_lshrrev_b32 v196, 19, v196
    v_lshrrev_b32 v197, 19, v197
    v_lshrrev_b32 v198, 19, v198
    v_lshrrev_b32 v199, 19, v199
    v_lshrrev_b32 v104, 19, v104
    v_lshrrev_b32 v105, 19, v105
    v_lshrrev_b32 v106, 19, v106
    v_lshrrev_b32_e64 v107, 19, v107
    v_mad_i32_i24 v193, v193, s52, v251
    v_mad_i32_i24 v194, v194, s52, v251
    v_mad_i32_i24 v195, v195, s52, v251
    v_mad_i32_i24 v196, v196, s52, v251
    v_mad_i32_i24 v197, v197, s52, v251
    v_mad_i32_i24 v198, v198, s52, v251
    v_mad_i32_i24 v199, v199, s52, v251
    v_mad_i32_i24 v104, v104, s52, v251
    v_mad_i32_i24 v105, v105, s52, v251
    v_mad_i32_i24 v106, v106, s52, v251
    v_mad_i32_i24 v107, v107, s52, v251
    v_and_b32 v250, 15, v0
    v_lshrrev_b32 v251, 5, v0
    v_lshlrev_b32 v251, 3, v251
    v_xor_b32 v251, v250, v251
    v_lshlrev_b32 v251, 4, v251
    v_lshrrev_b32 v227, 4, v0
    v_lshl_add_u32 v1, v227, 9, v251
    v_lshrrev_b32 v251, 3, v250
    v_lshlrev_b32 v251, 1, v251
    v_xor_b32_e64 v251, v227, v251
    v_lshl_add_u32 v251, v250, 2, v251
    v_lshlrev_b32 v2, 3, v251
    v_lshlrev_b32 v188, 3, v0
    v_mul_u32_u24 v230, 288, v250
    v_lshl_add_u32 v230, v227, 3, v230
    v_add_u32 v230, s47, v230
    v_and_b32 v251, 1, v227
    v_lshlrev_b32 v251, 5, v251
    v_add_u32 v228, v230, v251
    v_xor_b32 v251, 32, v251
    v_add_u32 v229, v230, v251
    s_mul_i32 s47, s40, 9216
    v_lshrrev_b32_e64 v250, 2, v0
    v_bfe_u32 v251, v0, 1, 1
    v_lshlrev_b32 v251, 3, v251
    v_xor_b32 v251, v250, v251
    v_lshlrev_b32 v251, 4, v251
    v_and_b32 v227, 3, v0
    v_lshl_add_u32 v251, v227, 9, v251
    v_and_b32_e64 v3, 1, v0
    v_lshl_add_u32 v251, v3, 3, v251
    s_and_b32 s52, s40, 1
    s_lshl_b32 s52, s52, 12
    s_add_u32 s53, s52, s47
    s_xor_b32 s52, s52, 4096
    s_add_u32 s52, s52, s47
    v_add_u32 v3, s52, v251
    v_add_u32 v14, s53, v251
    v_xor_b32 v4, 8, v3
    v_xor_b32 v15, 8, v14
    s_add_u32 m0, s70, 0
    s_add_u32 s45, s71, 0
    buffer_load_dwordx4 v193, s[16:19], s45 offen lds
    v_lshrrev_b32 v251, 5, v0
    v_lshlrev_b32 v251, 1, v251
    v_xor_b32_e64 v251, v227, v251
    v_lshl_add_u32 v251, v250, 2, v251
    v_lshlrev_b32 v251, 3, v251
    v_add_u32 v5, s47, v251
    v_add_u32 v7, 4096, v6
    v_add_u32 v8, 8192, v6
    v_lshrrev_b32_e64 v250, 2, v0
    v_mul_u32_u24 v250, 288, v250
    v_and_b32_e64 v251, 3, v0
    v_lshl_add_u32 v250, v251, 3, v250
    v_add_u32_e64 v191, 0, v250
    v_bfe_u32 v250, v0, 4, 1
    v_mul_u32_u24 v250, 4608, v250
    v_add_u32 v189, v191, v250
    v_sub_u32 v190, v191, v250
    v_add_u32 v190, 4608, v190
    s_add_u32 s52, s40, 0
    s_and_b32 s52, s52, 3
    s_lshl_b32 s53, s52, 12
    s_add_u32 s53, s53, 73728
    v_add_u32_e64 v88, s53, v6
    s_lshl_b32 s53, s52, 9
    s_add_u32 s53, s53, 90112
    v_add_u32 v182, s53, v188
    v_add_u32_e64 v92, s70, v88
    s_add_u32 s52, s40, 1
    s_and_b32 s52, s52, 3
    s_lshl_b32 s53, s52, 12
    s_add_u32 s53, s53, 73728
    v_add_u32 v89, s53, v6
    s_lshl_b32 s53, s52, 9
    s_add_u32 s53, s53, 90112
    v_add_u32 v183, s53, v188
    v_add_u32_e64 v93, s70, v89
    s_add_u32 s52, s40, 2
    s_and_b32 s52, s52, 3
    s_lshl_b32 s53, s52, 12
    s_add_u32 s53, s53, 73728
    s_add_u32 m0, s70, 4096
    s_add_u32 s45, s71, 8128
    buffer_load_dwordx4 v194, s[16:19], s45 offen lds
    v_add_u32 v90, s53, v6
    s_lshl_b32 s53, s52, 9
    s_add_u32 s53, s53, 90112
    v_add_u32 v184, s53, v188
    v_add_u32_e64 v94, s70, v90
    s_add_u32 s52, s40, 3
    s_and_b32 s52, s52, 3
    s_lshl_b32 s53, s52, 12
    s_add_u32 s53, s53, 73728
    v_add_u32 v91, s53, v6
    s_lshl_b32 s53, s52, 9
    s_add_u32 s53, s53, 90112
    v_add_u32 v185, s53, v188
    v_add_u32_e64 v95, s70, v91
    s_sub_u32 s54, 63, s42
    s_add_u32 s55, s40, 60
    s_cmp_ge_u32 s55, s54
    s_cselect_b32 s46, 4, 99
    s_mov_b32 s51, 0
    s_mov_b32 s44, s47
    s_lshl_b32 s68, s48, 8
    s_add_u32 s68, s68, 2304000
    s_and_b32 s52, s40, 1
    s_lshl_b32 s52, s52, 7
    s_add_u32 s68, s68, s52
    s_lshr_b32 s52, s40, 1
    s_and_b32 s52, s52, s50
    s_cmp_eq_u32 s52, 1
    s_cselect_b32 s68, s68, 0x40000000
    s_lshl_b32 s99, s2, 8
    s_add_u32 s99, s99, 9684480
    s_mul_i32 s52, s42, 1792
    s_sub_u32 s52, s52, 768
    s_mul_i32 s53, s42, 62
    s_cmp_eq_u32 s43, s53
    s_cselect_b32 s52, 0, s52
    v_mov_b32_e64 v248, 0x40000000
    s_xor_b32 s53, s99, 256
    s_add_u32 s52, s52, s99
    s_nop 0
    v_writelane_b32 v248, s99, 0
    v_writelane_b32 v248, s53, 1
    s_add_u32 m0, s70, 8192
    s_add_u32 s45, s71, 16256
    buffer_load_dwordx4 v195, s[16:19], s45 offen lds
    v_writelane_b32 v248, s52, 2
    s_mov_b32 s52, 9748992
    s_mov_b32 s53, 9749248
    v_writelane_b32 v248, s52, 3
    v_writelane_b32 v248, s53, 4
    s_sub_u32 s99, s99, 163584
    v_lshrrev_b32 v226, 4, v0
    v_min_u32 v226, 1, v226
    v_lshlrev_b32 v226, 20, v226
    v_add_u32 v226, v226, v0
    s_and_b32 s52, s6, 7
    s_lshl_b32 s52, s52, 7
    s_add_u32 s52, s52, 2368000
    v_lshl_add_u32 v226, v226, 10, s52
    s_getreg_b32 s74, hwreg(HW_REG_XCC_ID, 0, 4)
    s_xor_b32 s52, s2, 1
    s_lshl_b32 s52, s52, 8
    s_add_u32 s52, s52, 9684484
    v_writelane_b32 v248, s52, 5
    s_lshr_b32 s3, s40, 1
    s_and_b32 s4, s40, 1
    v_and_b32 v57, 15, v0
    v_lshrrev_b32_e64 v53, 4, v0
    v_mul_u32_u24 v54, 288, v57
    v_mov_b32 v56, 0x40000000
    s_lshl_b32 s52, s48, 1
    s_add_u32 s52, s52, s3
    s_lshl_b32 s52, s52, 4
    v_add_u32_e64 v52, s52, v57
    s_mul_i32 s53, s48, 9216
    s_mul_i32 s54, s4, 4608
    v_add_u32_e64 v54, s53, v54
    s_sub_u32 s55, 4608, s54
    v_add_u32 v55, s55, v54
    v_add_u32 v54, s54, v54
    v_lshl_add_u32 v236, v53, 4, v54
    v_lshl_add_u32 v237, v53, 4, v55
    v_lshl_add_u32 v9, v53, 3, v54
    s_lshl_b32 s55, s4, 11
    s_add_u32 s5, s55, 2304000
    s_add_u32 s6, s55, 4608000
    s_sub_u32 s55, 4096, s55
    s_lshl_b32 s52, s4, 11
    s_add_u32 s52, s52, 9616384
    v_lshrrev_b32 v54, 2, v57
    v_cmp_eq_u32 vcc, v54, v53
    v_lshl_add_u32 v244, v57, 4, s52
    s_nop 0
    v_cndmask_b32 v244, v56, v244, vcc
    s_lshl_b32 s43, s40, 6
    v_lshlrev_b32 v246, 3, v0
    v_add_u32 v246, 4096, v246
    v_add_u32_e64 v247, s47, v6
    v_add_u32 v247, 73728, v247
    s_xor_b32 s52, s3, 1
    v_xor_b32 v54, s52, v53
    v_lshl_add_u32 v54, v54, 4, v57
    s_lshl_b32 s52, s40, 2
    s_add_u32 s52, s52, 156672
    v_lshl_add_u32 v245, v54, 4, s52
    s_sub_u32 s38, 0, s4
    s_mov_b32 s39, s38
    s_xor_b32 s52, s40, 1
    s_mul_i32 s52, s52, 9216
    s_add_u32 s36, s52, 110592
    s_xor_b32 s52, s40, 2
    s_mul_i32 s52, s52, 9216
    s_add_u32 s37, s52, 73728
    s_xor_b32 s52, s40, 3
    s_mul_i32 s52, s52, 9216
    s_add_u32 s7, s52, 73728
    s_mul_i32 s52, s41, 4000
    s_add_u32 s53, s52, 3999
    s_mov_b32 s54, 4608
    v_lshrrev_b32 v54, 4, v52
    v_and_b32 v55, 15, v52
    v_mul_lo_u32 v54, v54, s54
    v_lshl_add_u32 v55, v53, 4, v55
    v_lshl_add_u32 v238, v55, 4, v54
    v_lshl_add_u32 v239, v55, 3, v54
    v_add_u32 v239, s55, v239
    v_add_u32 v240, -1, v52
    v_cmp_eq_u32 vcc, s52, v52
    v_lshrrev_b32 v54, 4, v240
    v_and_b32_e64 v55, 15, v240
    v_mul_lo_u32 v54, v54, s54
    v_lshl_add_u32 v55, v53, 4, v55
    v_lshl_add_u32 v240, v55, 4, v54
    v_lshl_add_u32 v241, v55, 3, v54
    v_add_u32 v241, s55, v241
    v_cndmask_b32 v240, v240, v56, vcc
    v_cndmask_b32 v241, v241, v56, vcc
    v_add_u32 v242, 1, v52
    v_cmp_eq_u32 vcc, s53, v52
    v_lshrrev_b32 v54, 4, v242
    v_and_b32_e64 v55, 15, v242
    v_mul_lo_u32 v54, v54, s54
    v_lshl_add_u32 v55, v53, 4, v55
    v_lshl_add_u32 v242, v55, 4, v54
    v_lshl_add_u32 v243, v55, 3, v54
    v_add_u32_e64 v243, s55, v243
    v_cndmask_b32 v242, v242, v56, vcc
    v_cndmask_b32 v243, v243, v56, vcc
    s_mul_i32 s26, s48, 9216
    s_mul_i32 s52, s3, 4608
    s_lshl_b32 s53, s4, 11
    s_add_u32 s52, s52, s53
    s_add_u32 s26, s26, s52
    s_xor_b32 s53, s42, 1
    s_sub_u32 s53, s53, s42
    s_mul_i32 s53, s53, 9216
    s_add_u32 s28, s26, s53
    s_cmp_ge_u32 s2, 248
    s_cselect_b32 s52, 2.0, 0
    s_mul_i32 s53, s52, s42
    s_sub_u32 s52, s52, s53
    s_add_u32 s28, s28, s52
    s_add_u32 s29, s26, s53
    s_lshl_b32 s52, s51, 30
    s_or_b32 s26, s29, s52
    s_lshl1_add_u32 s27, s2, s3
    s_mul_i32 s27, s27, 5120
    s_add_u32 s27, s27, s52
    s_lshl_b32 s52, s4, 9
    s_add_u32 s52, s52, 6912000
    s_add_u32 s27, s27, s52
    s_mov_b64 exec, 0
    s_cmp_eq_u32 s40, 0
    s_cbranch_scc1 L_tr
    s_cmp_eq_u32 s40, 1
    s_cbranch_scc1 L_t0
    s_cmp_eq_u32 s40, 2
    s_cbranch_scc1 L_t1
    s_branch L_t2
L_last:
    s_waitcnt vmcnt(9)
    s_mov_b32 s54, 0
L_late:
    v_cmp_ne_u32 s[56:57], s98, v252
    s_add_u32 s16, s12, 9533440
    s_addc_u32 s17, s13, 0
    s_mov_b32 s18, 82944
    s_add_u32 s44, s47, 41472
    s_mov_b32 s24, -41472
    s_lshr_b32 s66, s40, 1
    s_lshl_b32 s66, s66, 30
    s_add_u32 s67, s66, 9570304
    s_add_u32 s66, s66, 9611776
    v_readlane_b32 s73, v252, 5
    s_sub_u32 s73, s73, s98
    s_and_b32 s52, s56, 31
    s_cbranch_scc0 L_lastb
    buffer_load_dword v252, v248, s[12:15], 0 offen sc1
    s_add_u32 s54, s54, 1
    s_waitcnt vmcnt(0)
    s_cmp_lt_u32 s54, 0x40000
    s_cbranch_scc1 L_late
    s_branch L_lastb
.p2align 12
L_tr:
    s_mov_b64 exec, -1
    s_waitcnt vmcnt(7)
    ds_read_b64 v[16:17], v228 offset:0
    ds_read_b64 v[18:19], v229 offset:0
    ds_read_b64 v[20:21], v228 offset:64
    ds_read_b64 v[22:23], v229 offset:64
    ds_read_b64 v[24:25], v228 offset:128
    ds_read_b64 v[26:27], v229 offset:128
    ds_read_b64 v[28:29], v228 offset:192
    ds_read_b64 v[30:31], v229 offset:192
    ds_read_b64 v[32:33], v230 offset:256
    s_and_b32 s52, s40, 1
    s_mul_i32 s54, s48, 9216
    s_add_u32 s54, s54, s75
    s_cmp_eq_u32 s50, 1
    s_cselect_b32 s54, s54, 0x40000000
    s_lshl_b32 s55, s52, 8
    s_add_u32 s55, s55, s54
    s_add_u32 s56, s55, 4096
    s_lshl_b32 s57, s52, 9
    s_add_u32 s57, s57, s54
    s_add_u32 s57, s57, 8192
    s_waitcnt lgkmcnt(0)
    v_mov_b32 v234, 0x3f803f80
    v_mov_b32 v228, 0
    v_mov_b32 v229, 0
    v_mov_b32 v230, 0
    v_mov_b32_e64 v231, 0
    v_dot2_f32_bf16 v228, v16, v234, v228
    v_dot2_f32_bf16 v229, v16, v16, v229
    v_dot2_f32_bf16 v230, v17, v234, v230
    v_dot2_f32_bf16 v231, v17, v17, v231
    v_dot2_f32_bf16 v228, v18, v234, v228
    s_add_u32 m0, s70, 12288
    s_add_u32 s45, s71, 24384
    buffer_load_dwordx4 v196, s[16:19], s45 offen lds
    v_dot2_f32_bf16 v229, v18, v18, v229
    v_dot2_f32_bf16 v230, v19, v234, v230
    v_dot2_f32_bf16 v231, v19, v19, v231
    v_dot2_f32_bf16 v228, v20, v234, v228
    v_dot2_f32_bf16 v229, v20, v20, v229
    s_add_u32 m0, s70, 16384
    s_add_u32 s45, s71, 32512
    buffer_load_dwordx4 v197, s[16:19], s45 offen lds
    v_dot2_f32_bf16 v230, v21, v234, v230
    v_dot2_f32_bf16 v231, v21, v21, v231
    v_dot2_f32_bf16 v228, v22, v234, v228
    v_dot2_f32_bf16 v229, v22, v22, v229
    v_dot2_f32_bf16 v230, v23, v234, v230
    s_add_u32 m0, s70, 20480
    s_add_u32 s45, s71, 40928
    buffer_load_dwordx4 v198, s[16:19], s45 offen lds
    v_dot2_f32_bf16 v231, v23, v23, v231
    v_dot2_f32_bf16 v228, v24, v234, v228
    v_dot2_f32_bf16 v229, v24, v24, v229
    v_dot2_f32_bf16 v230, v25, v234, v230
    v_dot2_f32_bf16 v231, v25, v25, v231
    s_add_u32 m0, s70, 24576
    s_add_u32 s45, s71, 49056
    buffer_load_dwordx4 v199, s[16:19], s45 offen lds
    v_dot2_f32_bf16 v228, v26, v234, v228
    v_dot2_f32_bf16 v229, v26, v26, v229
    v_dot2_f32_bf16 v230, v27, v234, v230
    v_dot2_f32_bf16 v231, v27, v27, v231
    v_dot2_f32_bf16 v228, v28, v234, v228
    s_add_u32 m0, s70, 28672
    s_add_u32 s45, s71, 57184
    buffer_load_dwordx4 v104, s[16:19], s45 offen lds
    v_dot2_f32_bf16 v229, v28, v28, v229
    v_dot2_f32_bf16 v230, v29, v234, v230
    v_dot2_f32_bf16 v231, v29, v29, v231
    v_dot2_f32_bf16 v228, v30, v234, v228
    v_dot2_f32_bf16 v229, v30, v30, v229
    s_add_u32 m0, s70, 32768
    s_add_u32 s45, s71, 65312
    buffer_load_dwordx4 v105, s[16:19], s45 offen lds
    v_dot2_f32_bf16 v230, v31, v234, v230
    v_dot2_f32_bf16 v231, v31, v31, v231
    v_dot2_f32_bf16 v228, v32, v234, v228
    v_dot2_f32_bf16 v229, v32, v32, v229
    v_dot2_f32_bf16 v230, v33, v234, v230
    s_add_u32 m0, s70, 36864
    s_add_u32 s45, s71, 73728
    buffer_load_dwordx4 v106, s[16:19], s45 offen lds
    v_dot2_f32_bf16 v231, v33, v33, v231
    v_lshlrev_b32_e64 v34, 16, v16
    v_and_b32 v35, 0xffff0000, v16
    v_lshlrev_b32_e64 v36, 16, v17
    v_and_b32 v37, 0xffff0000, v17
    s_mov_b32 exec_hi, 0
    s_add_u32 m0, s69, 40960
    s_add_u32 s45, s71, 81856
    buffer_load_dwordx4 v107, s[16:19], s45 offen lds
    s_mov_b32 exec_hi, -1
    v_pk_add_f32 v[228:229], v[228:229], v[230:231]
    v_mov_b32 v230, v228
    v_lshlrev_b32 v38, 16, v18
    v_and_b32 v39, 0xffff0000, v18
    v_mov_b32 v231, v229
    v_lshlrev_b32 v40, 16, v19
    v_and_b32 v41, 0xffff0000, v19
    s_nop 0
    v_permlane32_swap_b32 v228, v230
    v_lshlrev_b32_e64 v42, 16, v20
    v_and_b32 v43, 0xffff0000, v20
    v_permlane32_swap_b32 v229, v231
    v_lshlrev_b32 v44, 16, v21
    v_and_b32 v45, 0xffff0000, v21
    v_add_f32 v228, v228, v230
    v_lshlrev_b32 v46, 16, v22
    v_and_b32 v47, 0xffff0000, v22
    v_add_f32 v229, v229, v231
    v_lshlrev_b32 v48, 16, v23
    v_and_b32 v49, 0xffff0000, v23
    v_mov_b32 v230, v228
    v_lshlrev_b32 v50, 16, v24
    v_and_b32 v51, 0xffff0000, v24
    v_mov_b32 v231, v229
    v_lshlrev_b32 v52, 16, v25
    v_and_b32 v53, 0xffff0000, v25
    s_nop 0
    v_permlane16_swap_b32 v228, v230
    v_lshlrev_b32_e64 v54, 16, v26
    v_and_b32 v55, 0xffff0000, v26
    v_permlane16_swap_b32 v229, v231
    v_lshlrev_b32 v56, 16, v27
    v_and_b32 v57, 0xffff0000, v27
    v_add_f32 v228, v228, v230
    v_lshlrev_b32 v58, 16, v28
    v_and_b32 v59, 0xffff0000, v28
    v_add_f32 v229, v229, v231
    v_lshlrev_b32 v60, 16, v29
    v_and_b32 v61, 0xffff0000, v29
    v_mul_f32 v230, 0x3be38e39, v228
    v_lshlrev_b32_e64 v62, 16, v30
    v_and_b32 v63, 0xffff0000, v30
    v_mul_f32 v231, v230, v230
    v_lshlrev_b32 v64, 16, v31
    v_and_b32 v65, 0xffff0000, v31
    v_mov_b32 v232, 0x3be38e39
    v_lshlrev_b32_e64 v66, 16, v32
    v_and_b32 v67, 0xffff0000, v32
    v_fma_f32 v228, v229, v232, -v231
    v_lshlrev_b32_e64 v68, 16, v33
    v_and_b32 v69, 0xffff0000, v33
    v_max_f32_e64 v228, 0, v228
    v_cvt_pk_bf16_f32 v228, v228, v228
    v_lshlrev_b32_e64 v228, 16, v228
    v_add_f32 v228, 0x3727c5ac, v228
    v_cvt_pk_bf16_f32 v228, v228, v228
    v_lshlrev_b32 v228, 16, v228
    v_sqrt_f32_e64 v228, v228
    s_nop 0
    v_cvt_pk_bf16_f32 v228, v228, v228
    v_lshlrev_b32 v228, 16, v228
    v_rcp_f32_e64 v228, v228
    s_nop 0
    v_mul_f32 v230, -v230, v228
    v_pk_fma_f32 v[34:35], v[34:35], v[228:229], v[230:231] op_sel_hi:[1,0,0]
    v_pk_fma_f32 v[36:37], v[36:37], v[228:229], v[230:231] op_sel_hi:[1,0,0]
    v_pk_fma_f32 v[38:39], v[38:39], v[228:229], v[230:231] op_sel_hi:[1,0,0]
    v_pk_fma_f32 v[40:41], v[40:41], v[228:229], v[230:231] op_sel_hi:[1,0,0]
    v_pk_fma_f32 v[42:43], v[42:43], v[228:229], v[230:231] op_sel_hi:[1,0,0]
    v_pk_fma_f32 v[44:45], v[44:45], v[228:229], v[230:231] op_sel_hi:[1,0,0]
    v_pk_fma_f32 v[46:47], v[46:47], v[228:229], v[230:231] op_sel_hi:[1,0,0]
    v_pk_fma_f32 v[48:49], v[48:49], v[228:229], v[230:231] op_sel_hi:[1,0,0]
    v_pk_fma_f32 v[50:51], v[50:51], v[228:229], v[230:231] op_sel_hi:[1,0,0]
    v_pk_fma_f32 v[52:53], v[52:53], v[228:229], v[230:231] op_sel_hi:[1,0,0]
    v_pk_fma_f32 v[54:55], v[54:55], v[228:229], v[230:231] op_sel_hi:[1,0,0]
    v_pk_fma_f32 v[56:57], v[56:57], v[228:229], v[230:231] op_sel_hi:[1,0,0]
    v_pk_fma_f32 v[58:59], v[58:59], v[228:229], v[230:231] op_sel_hi:[1,0,0]
    v_pk_fma_f32 v[60:61], v[60:61], v[228:229], v[230:231] op_sel_hi:[1,0,0]
    v_pk_fma_f32 v[62:63], v[62:63], v[228:229], v[230:231] op_sel_hi:[1,0,0]
    v_pk_fma_f32 v[64:65], v[64:65], v[228:229], v[230:231] op_sel_hi:[1,0,0]
    v_pk_fma_f32 v[66:67], v[66:67], v[228:229], v[230:231] op_sel_hi:[1,0,0]
    v_pk_fma_f32 v[68:69], v[68:69], v[228:229], v[230:231] op_sel_hi:[1,0,0]
    v_cvt_pk_bf16_f32 v146, v34, v35
    v_cvt_pk_bf16_f32 v147, v36, v37
    v_cvt_pk_bf16_f32 v148, v38, v39
    v_cvt_pk_bf16_f32 v149, v40, v41
    v_cvt_pk_bf16_f32 v150, v42, v43
    v_cvt_pk_bf16_f32 v151, v44, v45
    v_cvt_pk_bf16_f32 v152, v46, v47
    v_cvt_pk_bf16_f32 v153, v48, v49
    v_cvt_pk_bf16_f32 v154, v50, v51
    v_cvt_pk_bf16_f32 v155, v52, v53
    v_cvt_pk_bf16_f32 v156, v54, v55
    v_cvt_pk_bf16_f32 v157, v56, v57
    v_cvt_pk_bf16_f32 v158, v58, v59
    v_cvt_pk_bf16_f32 v159, v60, v61
    v_cvt_pk_bf16_f32 v160, v62, v63
    v_cvt_pk_bf16_f32 v161, v64, v65
    v_cvt_pk_bf16_f32 v162, v66, v67
    v_cvt_pk_bf16_f32 v163, v68, v69
    s_cmp_lt_u32 s40, 2
    s_cbranch_scc1 L_nop
    buffer_store_dwordx4 v[146:149], v1, s[12:15], s55 offen offset:0 sc1
    v_mov_b32 v16, v162
    v_mov_b32 v17, v163
    buffer_store_dwordx4 v[150:153], v1, s[12:15], s55 offen offset:2048 sc1
    v_mov_b32 v18, v162
    v_mov_b32 v19, v163
    buffer_store_dwordx4 v[154:157], v1, s[12:15], s56 offen offset:0 sc1
    buffer_store_dwordx4 v[158:161], v1, s[12:15], s56 offen offset:2048 sc1
    v_permlane16_swap_b32 v16, v18
    v_permlane16_swap_b32 v17, v19
    s_mov_b32 s52, 0xffff
    s_mov_b64 exec, 0xffff
    v_mov_b32 v20, 0x3f80
    v_bfi_b32 v16, s52, v20, v16
    s_mov_b32 exec_lo, 0xffff
    s_mov_b32 exec_hi, 0xffff
    buffer_store_dwordx4 v[16:19], v2, s[12:15], s57 offen sc1
    s_mov_b64 exec, -1
    s_waitcnt vmcnt(5)
    s_branch L_bar1
L_nop:
    s_mov_b64 exec, 0
    s_cmp_eq_u32 s40, 0
    s_cbranch_scc1 L_t3
    s_branch L_tr2
L_tr2:
    s_mov_b64 exec, -1
    s_waitcnt vmcnt(0)
L_bar1:
    v_add_u32 v1, s47, v1
    v_add_u32_e64 v2, s47, v2
    s_mul_i32 s52, s41, 125
    s_mul_i32 s53, s42, 63
    s_add_u32 s52, s52, s53
    s_lshl_b32 s52, s52, 8
    s_add_u32 s52, s52, 2304000
    s_lshl_b32 s53, s40, 8
    s_add_u32 s52, s52, s53
    v_lshrrev_b32 v250, 5, v0
    v_lshlrev_b32 v250, 30, v250
    v_and_b32 v251, 1, v0
    v_lshl_add_u32 v250, v251, 7, v250
    v_lshrrev_b32_e64 v251, 1, v0
    v_lshl_add_u32 v250, v251, 10, v250
    v_add_u32_e64 v249, s52, v250
    s_waitcnt lgkmcnt(0)
    s_barrier
    ds_read_b64_tr_b16 a[0:1], v189 offset:0
    ds_read_b64_tr_b16 a[2:3], v190 offset:0
    ds_read_b64_tr_b16 a[18:19], v189 offset:32
    ds_read_b64_tr_b16 a[20:21], v190 offset:32
    ds_read_b64_tr_b16 a[36:37], v189 offset:64
    ds_read_b64_tr_b16 a[38:39], v190 offset:64
    ds_read_b64_tr_b16 a[4:5], v189 offset:9216
    ds_read_b64_tr_b16 a[6:7], v190 offset:9216
    ds_read_b64_tr_b16 a[22:23], v189 offset:9248
    ds_read_b64_tr_b16 a[24:25], v190 offset:9248
    ds_read_b64_tr_b16 a[40:41], v189 offset:9280
    ds_read_b64_tr_b16 a[42:43], v190 offset:9280
    s_waitcnt lgkmcnt(6)
    s_nop 0
    v_mfma_f32_16x16x32_bf16 v[16:19], a[0:3], v[146:149], 0
    ds_read_b64_tr_b16 a[8:9], v189 offset:18432
    ds_read_b64_tr_b16 a[10:11], v190 offset:18432
    ds_write_b128 v88, v[146:149] offset:0
    v_mfma_f32_16x16x32_bf16 v[20:23], a[18:21], v[146:149], 0
    ds_read_b64_tr_b16 a[26:27], v189 offset:18464
    ds_read_b64_tr_b16 a[28:29], v190 offset:18464
    ds_write_b128 v88, v[150:153] offset:1024
    v_mfma_f32_16x16x32_bf16 v[24:27], a[36:39], v[146:149], 0
    ds_read_b64_tr_b16 a[44:45], v189 offset:18496
    ds_read_b64_tr_b16 a[46:47], v190 offset:18496
    ds_write_b128 v88, v[154:157] offset:2048
    s_waitcnt lgkmcnt(6)
    s_nop 0
    v_mfma_f32_16x16x32_bf16 v[16:19], a[4:7], v[150:153], v[16:19]
    ds_read_b64_tr_b16 a[12:13], v189 offset:27648
    ds_read_b64_tr_b16 a[14:15], v190 offset:27648
    ds_write_b128 v88, v[158:161] offset:3072
    v_mfma_f32_16x16x32_bf16 v[20:23], a[22:25], v[150:153], v[20:23]
    ds_read_b64_tr_b16 a[30:31], v189 offset:27680
    ds_read_b64_tr_b16 a[32:33], v190 offset:27680
    ds_write_b64 v182, v[162:163]
    v_mfma_f32_16x16x32_bf16 v[24:27], a[40:43], v[150:153], v[24:27]
    ds_read_b64_tr_b16 a[48:49], v189 offset:27712
    ds_read_b64_tr_b16 a[50:51], v190 offset:27712
    buffer_load_dword v253, off, s[20:23], 0 sc1
    s_waitcnt lgkmcnt(6)
    s_nop 0
    v_mfma_f32_16x16x32_bf16 v[16:19], a[8:11], v[154:157], v[16:19]
    ds_read_b64_tr_b16 a[16:17], v191 offset:36864
    ds_read_b64_tr_b16 a[34:35], v191 offset:36896
    v_mfma_f32_16x16x32_bf16 v[20:23], a[26:29], v[154:157], v[20:23]
    ds_read_b64_tr_b16 a[52:53], v191 offset:36928
    ds_read_b64_tr_b16 a[54:55], v189 offset:96
    v_mfma_f32_16x16x32_bf16 v[24:27], a[44:47], v[154:157], v[24:27]
    ds_read_b64_tr_b16 a[56:57], v190 offset:96
    ds_read_b64_tr_b16 a[72:73], v189 offset:128
    s_waitcnt lgkmcnt(6)
    s_nop 0
    v_mfma_f32_16x16x32_bf16 v[16:19], a[12:15], v[158:161], v[16:19]
    ds_read_b64_tr_b16 a[74:75], v190 offset:128
    ds_read_b64_tr_b16 a[90:91], v189 offset:160
    v_mfma_f32_16x16x32_bf16 v[20:23], a[30:33], v[158:161], v[20:23]
    ds_read_b64_tr_b16 a[92:93], v190 offset:160
    ds_read_b64_tr_b16 a[58:59], v189 offset:9312
    v_mfma_f32_16x16x32_bf16 v[24:27], a[48:51], v[158:161], v[24:27]
    ds_read_b64_tr_b16 a[60:61], v190 offset:9312
    ds_read_b64_tr_b16 a[76:77], v189 offset:9344
    s_waitcnt lgkmcnt(3)
    s_nop 0
    v_mfma_f32_16x16x32_bf16 v[28:31], a[54:57], v[146:149], 0
    ds_read_b64_tr_b16 a[78:79], v190 offset:9344
    ds_read_b64_tr_b16 a[94:95], v189 offset:9376
    v_mfma_f32_16x16x32_bf16 v[32:35], a[72:75], v[146:149], 0
    ds_read_b64_tr_b16 a[96:97], v190 offset:9376
    ds_read_b64_tr_b16 a[62:63], v189 offset:18528
    v_mfma_f32_16x16x32_bf16 v[36:39], a[90:93], v[146:149], 0
    ds_read_b64_tr_b16 a[64:65], v190 offset:18528
    ds_read_b64_tr_b16 a[80:81], v189 offset:18560
    v_mfma_f32_16x16x16_bf16 v[16:19], a[16:17], v[162:163], v[16:19]
    ds_read_b64_tr_b16 a[82:83], v190 offset:18560
    ds_read_b64_tr_b16 a[98:99], v189 offset:18592
    v_mfma_f32_16x16x16_bf16 v[20:23], a[34:35], v[162:163], v[20:23]
    ds_read_b64_tr_b16 a[100:101], v190 offset:18592
    ds_read_b64_tr_b16 a[66:67], v189 offset:27744
    v_mfma_f32_16x16x16_bf16 v[24:27], a[52:53], v[162:163], v[24:27]
    ds_read_b64_tr_b16 a[68:69], v190 offset:27744
    ds_read_b64_tr_b16 a[84:85], v189 offset:27776
    s_waitcnt lgkmcnt(9)
    s_nop 0
    v_mfma_f32_16x16x32_bf16 v[28:31], a[58:61], v[150:153], v[28:31]
    ds_read_b64_tr_b16 a[86:87], v190 offset:27776
    ds_read_b64_tr_b16 a[102:103], v189 offset:27808
    v_mfma_f32_16x16x32_bf16 v[32:35], a[76:79], v[150:153], v[32:35]
    ds_read_b64_tr_b16 a[104:105], v190 offset:27808
    ds_read_b64_tr_b16 a[70:71], v191 offset:36960
    v_mfma_f32_16x16x32_bf16 v[36:39], a[94:97], v[150:153], v[36:39]
    ds_read_b64_tr_b16 a[88:89], v191 offset:36992
    ds_read_b64_tr_b16 a[106:107], v191 offset:37024
    s_waitcnt lgkmcnt(9)
    s_nop 0
    v_mfma_f32_16x16x32_bf16 v[28:31], a[62:65], v[154:157], v[28:31]
    ds_read_b64_tr_b16 a[0:1], v189 offset:192
    ds_read_b64_tr_b16 a[2:3], v190 offset:192
    v_mfma_f32_16x16x32_bf16 v[32:35], a[80:83], v[154:157], v[32:35]
    ds_read_b64_tr_b16 a[18:19], v189 offset:224
    ds_read_b64_tr_b16 a[20:21], v190 offset:224
    v_mfma_f32_16x16x32_bf16 v[36:39], a[98:101], v[154:157], v[36:39]
    ds_read_b64_tr_b16 a[36:37], v189 offset:256
    ds_read_b64_tr_b16 a[38:39], v190 offset:256
    s_waitcnt lgkmcnt(9)
    s_nop 0
    v_mfma_f32_16x16x32_bf16 v[28:31], a[66:69], v[158:161], v[28:31]
    ds_read_b64_tr_b16 a[4:5], v189 offset:9408
    ds_read_b64_tr_b16 a[6:7], v190 offset:9408
    v_mfma_f32_16x16x32_bf16 v[32:35], a[84:87], v[158:161], v[32:35]
    ds_read_b64_tr_b16 a[22:23], v189 offset:9440
    ds_read_b64_tr_b16 a[24:25], v190 offset:9440
    v_mfma_f32_16x16x32_bf16 v[36:39], a[102:105], v[158:161], v[36:39]
    ds_read_b64_tr_b16 a[40:41], v189 offset:9472
    ds_read_b64_tr_b16 a[42:43], v190 offset:9472
    s_waitcnt lgkmcnt(6)
    s_nop 0
    v_mfma_f32_16x16x32_bf16 v[40:43], a[0:3], v[146:149], 0
    ds_read_b64_tr_b16 a[8:9], v189 offset:18624
    ds_read_b64_tr_b16 a[10:11], v190 offset:18624
    v_mfma_f32_16x16x32_bf16 v[44:47], a[18:21], v[146:149], 0
    ds_read_b64_tr_b16 a[26:27], v189 offset:18656
    ds_read_b64_tr_b16 a[28:29], v190 offset:18656
    v_mfma_f32_16x16x32_bf16 v[48:51], a[36:39], v[146:149], 0
    ds_read_b64_tr_b16 a[44:45], v189 offset:18688
    ds_read_b64_tr_b16 a[46:47], v190 offset:18688
    v_mfma_f32_16x16x16_bf16 v[28:31], a[70:71], v[162:163], v[28:31]
    ds_read_b64_tr_b16 a[12:13], v189 offset:27840
    ds_read_b64_tr_b16 a[14:15], v190 offset:27840
    v_mfma_f32_16x16x16_bf16 v[32:35], a[88:89], v[162:163], v[32:35]
    ds_read_b64_tr_b16 a[30:31], v189 offset:27872
    ds_read_b64_tr_b16 a[32:33], v190 offset:27872
    v_mfma_f32_16x16x16_bf16 v[36:39], a[106:107], v[162:163], v[36:39]
    ds_read_b64_tr_b16 a[48:49], v189 offset:27904
    ds_read_b64_tr_b16 a[50:51], v190 offset:27904
    s_waitcnt lgkmcnt(12)
    s_nop 0
    v_mfma_f32_16x16x32_bf16 v[40:43], a[4:7], v[150:153], v[40:43]
    ds_read_b64_tr_b16 a[16:17], v191 offset:37056
    ds_read_b64_tr_b16 a[34:35], v191 offset:37088
    v_mfma_f32_16x16x32_bf16 v[44:47], a[22:25], v[150:153], v[44:47]
    ds_read_b64_tr_b16 a[52:53], v191 offset:37120
    v_mfma_f32_16x16x32_bf16 v[48:51], a[40:43], v[150:153], v[48:51]
    s_waitcnt lgkmcnt(9)
    v_mfma_f32_16x16x32_bf16 v[40:43], a[8:11], v[154:157], v[40:43]
    v_mfma_f32_16x16x32_bf16 v[44:47], a[26:29], v[154:157], v[44:47]
    v_mfma_f32_16x16x32_bf16 v[48:51], a[44:47], v[154:157], v[48:51]
    s_waitcnt lgkmcnt(3)
    v_mfma_f32_16x16x32_bf16 v[40:43], a[12:15], v[158:161], v[40:43]
    v_mfma_f32_16x16x32_bf16 v[44:47], a[30:33], v[158:161], v[44:47]
    v_mfma_f32_16x16x32_bf16 v[48:51], a[48:51], v[158:161], v[48:51]
    s_waitcnt lgkmcnt(0)
    s_nop 2
    v_mfma_f32_16x16x16_bf16 v[40:43], a[16:17], v[162:163], v[40:43]
    v_mfma_f32_16x16x16_bf16 v[44:47], a[34:35], v[162:163], v[44:47]
    v_mfma_f32_16x16x16_bf16 v[48:51], a[52:53], v[162:163], v[48:51]
    s_nop 7
    v_mov_b32 v228, 0xc0135761
    v_mov_b32 v230, 0xbdd2d3e8
    v_mov_b32 v232, 1.0
    s_barrier
    v_lshrrev_b32 v255, 3, v0
    v_min_u32 v255, 1, v255
    v_lshlrev_b32 v255, 30, v255
    v_add_u32_e64 v255, v255, v6
    s_mov_b32 s57, 0
    s_waitcnt vmcnt(0)
L_tag:
    v_readfirstlane_b32 s98, v253
    s_add_u32 s57, s57, 1
    s_cmp_lg_u32 s98, 0
    s_cbranch_scc1 L_tag_ok
    buffer_load_dword v253, off, s[20:23], 0 sc1
    s_waitcnt vmcnt(0)
    s_cmp_lt_u32 s57, 0x40000
    s_cbranch_scc1 L_tag
L_tag_ok:
    s_bfe_u32 s57, s98, 393227
    s_mul_i32 s57, s57, 2621440
    s_add_u32 s57, s57, 12582912
    s_cmp_lg_u32 s57, s75
    s_cbranch_scc1 L_moved
L_movedb:
    s_add_u32 s68, s68, s75
    v_mov_b32 v104, s98
    v_mov_b32 v105, s98
    v_mov_b32 v106, s98
    v_mov_b32_e64 v107, s98
    buffer_store_dwordx4 v[104:107], v255, s[12:15], s68 offen sc1
    s_mul_i32 s57, s41, 125
    s_mul_i32 s58, s42, 63
    s_add_u32 s58, s58, s57
    s_mul_i32 s58, s58, 9216
    s_add_u32 s58, s58, s75
    s_add_u32 s16, s12, s58
    s_addc_u32 s17, s13, 0
    s_sub_u32 s59, 63, s42
    s_mul_i32 s18, s59, 9216
    s_mov_b32 s19, 0x20000
    v_pk_mul_f32 v[52:53], v[16:17], v[16:17]
    v_pk_mul_f32 v[54:55], v[18:19], v[18:19]
    v_pk_mul_f32 v[56:57], v[20:21], v[20:21]
    v_pk_mul_f32 v[58:59], v[22:23], v[22:23]
    v_pk_mul_f32 v[60:61], v[24:25], v[24:25]
    v_pk_mul_f32 v[62:63], v[26:27], v[26:27]
    v_pk_mul_f32 v[64:65], v[28:29], v[28:29]
    v_pk_mul_f32 v[66:67], v[30:31], v[30:31]
    v_pk_mul_f32 v[68:69], v[32:33], v[32:33]
    v_pk_mul_f32 v[70:71], v[34:35], v[34:35]
    v_pk_mul_f32 v[72:73], v[36:37], v[36:37]
    v_pk_mul_f32 v[74:75], v[38:39], v[38:39]
    v_pk_mul_f32 v[76:77], v[40:41], v[40:41]
    v_pk_mul_f32 v[78:79], v[42:43], v[42:43]
    v_pk_mul_f32 v[80:81], v[44:45], v[44:45]
    v_pk_mul_f32 v[82:83], v[46:47], v[46:47]
    v_pk_mul_f32 v[84:85], v[48:49], v[48:49]
    v_pk_mul_f32 v[86:87], v[50:51], v[50:51]
    v_pk_fma_f32 v[52:53], v[52:53], v[230:231], v[228:229] op_sel_hi:[1,0,0]
    v_pk_fma_f32 v[54:55], v[54:55], v[230:231], v[228:229] op_sel_hi:[1,0,0]
    v_pk_fma_f32 v[56:57], v[56:57], v[230:231], v[228:229] op_sel_hi:[1,0,0]
    v_pk_fma_f32 v[58:59], v[58:59], v[230:231], v[228:229] op_sel_hi:[1,0,0]
    v_pk_fma_f32 v[60:61], v[60:61], v[230:231], v[228:229] op_sel_hi:[1,0,0]
    v_pk_fma_f32 v[62:63], v[62:63], v[230:231], v[228:229] op_sel_hi:[1,0,0]
    v_pk_fma_f32 v[64:65], v[64:65], v[230:231], v[228:229] op_sel_hi:[1,0,0]
    v_pk_fma_f32 v[66:67], v[66:67], v[230:231], v[228:229] op_sel_hi:[1,0,0]
    v_pk_fma_f32 v[68:69], v[68:69], v[230:231], v[228:229] op_sel_hi:[1,0,0]
    v_pk_fma_f32 v[70:71], v[70:71], v[230:231], v[228:229] op_sel_hi:[1,0,0]
    v_pk_fma_f32 v[72:73], v[72:73], v[230:231], v[228:229] op_sel_hi:[1,0,0]
    v_pk_fma_f32 v[74:75], v[74:75], v[230:231], v[228:229] op_sel_hi:[1,0,0]
    v_pk_fma_f32 v[76:77], v[76:77], v[230:231], v[228:229] op_sel_hi:[1,0,0]
    v_pk_fma_f32 v[78:79], v[78:79], v[230:231], v[228:229] op_sel_hi:[1,0,0]
    v_pk_fma_f32 v[80:81], v[80:81], v[230:231], v[228:229] op_sel_hi:[1,0,0]
    v_pk_fma_f32 v[82:83], v[82:83], v[230:231], v[228:229] op_sel_hi:[1,0,0]
    v_pk_fma_f32 v[84:85], v[84:85], v[230:231], v[228:229] op_sel_hi:[1,0,0]
    v_pk_fma_f32 v[86:87], v[86:87], v[230:231], v[228:229] op_sel_hi:[1,0,0]
    v_pk_mul_f32 v[52:53], v[52:53], v[16:17]
    v_pk_mul_f32 v[54:55], v[54:55], v[18:19]
    v_pk_mul_f32 v[56:57], v[56:57], v[20:21]
    v_pk_mul_f32 v[58:59], v[58:59], v[22:23]
    v_pk_mul_f32 v[60:61], v[60:61], v[24:25]
    v_pk_mul_f32 v[62:63], v[62:63], v[26:27]
    v_pk_mul_f32 v[64:65], v[64:65], v[28:29]
    v_pk_mul_f32 v[66:67], v[66:67], v[30:31]
    v_pk_mul_f32 v[68:69], v[68:69], v[32:33]
    v_pk_mul_f32 v[70:71], v[70:71], v[34:35]
    v_pk_mul_f32 v[72:73], v[72:73], v[36:37]
    v_pk_mul_f32 v[74:75], v[74:75], v[38:39]
    v_pk_mul_f32 v[76:77], v[76:77], v[40:41]
    v_pk_mul_f32 v[78:79], v[78:79], v[42:43]
    v_pk_mul_f32 v[80:81], v[80:81], v[44:45]
    v_pk_mul_f32 v[82:83], v[82:83], v[46:47]
    v_pk_mul_f32 v[84:85], v[84:85], v[48:49]
    v_pk_mul_f32 v[86:87], v[86:87], v[50:51]
    v_exp_f32 v52, v52
    v_exp_f32 v53, v53
    v_exp_f32 v54, v54
    v_exp_f32 v55, v55
    v_exp_f32 v56, v56
    v_exp_f32 v57, v57
    v_exp_f32 v58, v58
    v_exp_f32 v59, v59
    v_exp_f32 v60, v60
    v_exp_f32 v61, v61
    v_exp_f32 v62, v62
    v_exp_f32 v63, v63
    v_exp_f32 v64, v64
    v_exp_f32 v65, v65
    v_exp_f32 v66, v66
    v_exp_f32 v67, v67
    v_exp_f32 v68, v68
    v_exp_f32 v69, v69
    v_exp_f32 v70, v70
    v_exp_f32 v71, v71
    v_exp_f32 v72, v72
    v_exp_f32 v73, v73
    v_exp_f32 v74, v74
    v_exp_f32 v75, v75
    v_exp_f32 v76, v76
    v_exp_f32 v77, v77
    v_exp_f32 v78, v78
    v_exp_f32 v79, v79
    v_exp_f32 v80, v80
    v_exp_f32 v81, v81
    v_exp_f32 v82, v82
    v_exp_f32 v83, v83
    v_exp_f32 v84, v84
    v_exp_f32 v85, v85
    v_exp_f32 v86, v86
    v_exp_f32 v87, v87
    v_pk_add_f32 v[52:53], v[52:53], v[232:233] op_sel_hi:[1,0]
    v_pk_add_f32 v[54:55], v[54:55], v[232:233] op_sel_hi:[1,0]
    v_pk_add_f32 v[56:57], v[56:57], v[232:233] op_sel_hi:[1,0]
    v_pk_add_f32 v[58:59], v[58:59], v[232:233] op_sel_hi:[1,0]
    v_pk_add_f32 v[60:61], v[60:61], v[232:233] op_sel_hi:[1,0]
    v_pk_add_f32 v[62:63], v[62:63], v[232:233] op_sel_hi:[1,0]
    v_pk_add_f32 v[64:65], v[64:65], v[232:233] op_sel_hi:[1,0]
    v_pk_add_f32 v[66:67], v[66:67], v[232:233] op_sel_hi:[1,0]
    v_pk_add_f32 v[68:69], v[68:69], v[232:233] op_sel_hi:[1,0]
    v_pk_add_f32 v[70:71], v[70:71], v[232:233] op_sel_hi:[1,0]
    v_pk_add_f32 v[72:73], v[72:73], v[232:233] op_sel_hi:[1,0]
    v_pk_add_f32 v[74:75], v[74:75], v[232:233] op_sel_hi:[1,0]
    v_pk_add_f32 v[76:77], v[76:77], v[232:233] op_sel_hi:[1,0]
    v_pk_add_f32 v[78:79], v[78:79], v[232:233] op_sel_hi:[1,0]
    v_pk_add_f32 v[80:81], v[80:81], v[232:233] op_sel_hi:[1,0]
    v_pk_add_f32 v[82:83], v[82:83], v[232:233] op_sel_hi:[1,0]
    v_pk_add_f32 v[84:85], v[84:85], v[232:233] op_sel_hi:[1,0]
    v_pk_add_f32 v[86:87], v[86:87], v[232:233] op_sel_hi:[1,0]
    v_rcp_f32 v52, v52
    v_rcp_f32 v53, v53
    v_rcp_f32 v54, v54
    v_rcp_f32 v55, v55
    v_rcp_f32 v56, v56
    v_rcp_f32 v57, v57
    v_rcp_f32 v58, v58
    v_rcp_f32 v59, v59
    v_rcp_f32 v60, v60
    v_rcp_f32 v61, v61
    v_rcp_f32 v62, v62
    v_rcp_f32 v63, v63
    v_rcp_f32 v64, v64
    v_rcp_f32 v65, v65
    v_rcp_f32 v66, v66
    v_rcp_f32 v67, v67
    v_rcp_f32 v68, v68
    v_rcp_f32 v69, v69
    buffer_load_dword v254, v226, s[12:15], s75 offen sc1
    v_rcp_f32 v70, v70
    v_rcp_f32 v71, v71
    v_rcp_f32 v72, v72
    v_rcp_f32 v73, v73
    v_rcp_f32 v74, v74
    v_rcp_f32 v75, v75
    v_rcp_f32 v76, v76
    v_rcp_f32 v77, v77
    v_rcp_f32 v78, v78
    v_rcp_f32 v79, v79
    v_rcp_f32 v80, v80
    v_rcp_f32 v81, v81
    v_rcp_f32 v82, v82
    v_rcp_f32 v83, v83
    v_rcp_f32 v84, v84
    v_rcp_f32 v85, v85
    v_rcp_f32 v86, v86
    v_rcp_f32 v87, v87
    v_pk_mul_f32 v[16:17], v[52:53], v[16:17]
    v_pk_mul_f32 v[18:19], v[54:55], v[18:19]
    v_pk_mul_f32 v[20:21], v[56:57], v[20:21]
    v_pk_mul_f32 v[22:23], v[58:59], v[22:23]
    v_pk_mul_f32 v[24:25], v[60:61], v[24:25]
    v_pk_mul_f32 v[26:27], v[62:63], v[26:27]
    buffer_load_dword v252, v249, s[12:15], s75 offen sc1
    v_pk_mul_f32 v[28:29], v[64:65], v[28:29]
    v_pk_mul_f32 v[30:31], v[66:67], v[30:31]
    v_pk_mul_f32 v[32:33], v[68:69], v[32:33]
    v_pk_mul_f32 v[34:35], v[70:71], v[34:35]
    v_pk_mul_f32 v[36:37], v[72:73], v[36:37]
    v_pk_mul_f32 v[38:39], v[74:75], v[38:39]
    v_pk_mul_f32 v[40:41], v[76:77], v[40:41]
    v_pk_mul_f32 v[42:43], v[78:79], v[42:43]
    v_pk_mul_f32 v[44:45], v[80:81], v[44:45]
    v_pk_mul_f32 v[46:47], v[82:83], v[46:47]
    v_pk_mul_f32 v[48:49], v[84:85], v[48:49]
    v_pk_mul_f32 v[50:51], v[86:87], v[50:51]
    s_waitcnt vmcnt(1)
    s_mov_b32 s57, 0
L_gm:
    v_cmp_ne_u32 vcc, s98, v254
    s_mul_i32 s58, s40, 9216
    s_add_u32 s60, s75, 2422784
    s_add_u32 s58, s58, 2385920
    s_add_u32 s58, s58, s75
    s_add_u32 s59, s58, 4608
    s_and_b32 vcc_lo, vcc_lo, 0xffff
    s_cbranch_scc0 L_gm_ok
    s_sleep 1
    buffer_load_dword v254, v226, s[12:15], s75 offen sc1
    s_add_u32 s57, s57, 1
    s_waitcnt vmcnt(0)
L_t0:
    s_cbranch_execz L_tr
    s_cmp_lt_u32 s57, 0x40000
    s_cbranch_scc1 L_gm
L_gm_ok:
    buffer_load_dwordx4 a[144:147], v6, s[12:15], s58 offen offset:0
    buffer_load_dwordx4 a[148:151], v6, s[12:15], s58 offen offset:1024
    buffer_load_dwordx4 a[152:155], v6, s[12:15], s58 offen offset:2048
    buffer_load_dwordx4 a[156:159], v6, s[12:15], s58 offen offset:3072
    s_mul_i32 s52, s73, 4608
    s_cmp_eq_u32 s42, 1
    s_cbranch_scc1 L_ln2
    s_add_u32 s52, s52, 2304000
    buffer_load_dwordx2 a[160:161], v246, s[12:15], s58 offen
    v_cvt_pk_bf16_f32 v208, v16, v17
    buffer_load_dwordx4 a[162:165], v6, s[12:15], s59 offen offset:0
    v_cvt_pk_bf16_f32 v209, v18, v19
    buffer_load_dwordx4 a[166:169], v6, s[12:15], s59 offen offset:1024
    v_cvt_pk_bf16_f32 v210, v20, v21
    buffer_load_dwordx4 a[170:173], v6, s[12:15], s59 offen offset:2048
    v_cvt_pk_bf16_f32 v211, v22, v23
    buffer_load_dwordx4 a[174:177], v6, s[12:15], s59 offen offset:3072
    v_cvt_pk_bf16_f32 v212, v24, v25
    buffer_load_dwordx2 a[178:179], v246, s[12:15], s59 offen
    v_cvt_pk_bf16_f32 v213, v26, v27
    buffer_load_dwordx4 a[180:183], v6, s[12:15], s60 offen offset:0
    v_cvt_pk_bf16_f32 v214, v28, v29
    buffer_load_dwordx4 a[184:187], v6, s[12:15], s60 offen offset:1024
    v_cvt_pk_bf16_f32 v215, v30, v31
    buffer_load_dwordx4 a[188:191], v6, s[12:15], s60 offen offset:2048
    v_cvt_pk_bf16_f32 v216, v32, v33
    buffer_load_dwordx4 a[192:195], v6, s[12:15], s60 offen offset:3072
    v_cvt_pk_bf16_f32 v217, v34, v35
    buffer_load_dwordx2 a[196:197], v246, s[12:15], s60 offen
    v_cvt_pk_bf16_f32 v218, v36, v37
    v_cvt_pk_bf16_f32 v219, v38, v39
    v_cvt_pk_bf16_f32 v220, v40, v41
    v_cvt_pk_bf16_f32 v221, v42, v43
    v_cvt_pk_bf16_f32 v222, v44, v45
    v_cvt_pk_bf16_f32 v223, v46, v47
    v_cvt_pk_bf16_f32 v224, v48, v49
    v_cvt_pk_bf16_f32 v225, v50, v51
    s_branch L_ug
L_ln2:
    s_nop 0
    s_add_u32 s52, s52, 4608000
    v_pk_add_f32 v[228:229], v[16:17], v[18:19]
    v_pk_add_f32 v[230:231], v[20:21], v[22:23]
    v_pk_mul_f32 v[232:233], v[16:17], v[16:17]
    v_pk_mul_f32 v[234:235], v[18:19], v[18:19]
    v_pk_fma_f32 v[232:233], v[20:21], v[20:21], v[232:233]
    v_pk_fma_f32 v[234:235], v[22:23], v[22:23], v[234:235]
    buffer_load_dwordx2 a[160:161], v246, s[12:15], s58 offen
    v_pk_add_f32 v[228:229], v[228:229], v[24:25]
    v_pk_fma_f32 v[232:233], v[24:25], v[24:25], v[232:233]
    v_pk_add_f32 v[230:231], v[230:231], v[26:27]
    v_pk_fma_f32 v[234:235], v[26:27], v[26:27], v[234:235]
    v_pk_add_f32 v[228:229], v[228:229], v[28:29]
    v_pk_fma_f32 v[232:233], v[28:29], v[28:29], v[232:233]
    buffer_load_dwordx4 a[162:165], v6, s[12:15], s59 offen offset:0
    v_pk_add_f32 v[230:231], v[230:231], v[30:31]
    v_pk_fma_f32 v[234:235], v[30:31], v[30:31], v[234:235]
    v_pk_add_f32 v[228:229], v[228:229], v[32:33]
    v_pk_fma_f32 v[232:233], v[32:33], v[32:33], v[232:233]
    v_pk_add_f32 v[230:231], v[230:231], v[34:35]
    v_pk_fma_f32 v[234:235], v[34:35], v[34:35], v[234:235]
    buffer_load_dwordx4 a[166:169], v6, s[12:15], s59 offen offset:1024
    v_pk_add_f32 v[228:229], v[228:229], v[36:37]
    v_pk_fma_f32 v[232:233], v[36:37], v[36:37], v[232:233]
    v_pk_add_f32 v[230:231], v[230:231], v[38:39]
    v_pk_fma_f32 v[234:235], v[38:39], v[38:39], v[234:235]
    v_pk_add_f32 v[228:229], v[228:229], v[40:41]
    v_pk_fma_f32 v[232:233], v[40:41], v[40:41], v[232:233]
    buffer_load_dwordx4 a[170:173], v6, s[12:15], s59 offen offset:2048
    v_pk_add_f32 v[230:231], v[230:231], v[42:43]
    v_pk_fma_f32 v[234:235], v[42:43], v[42:43], v[234:235]
    v_pk_add_f32 v[228:229], v[228:229], v[44:45]
    v_pk_fma_f32 v[232:233], v[44:45], v[44:45], v[232:233]
    v_pk_add_f32 v[230:231], v[230:231], v[46:47]
    v_pk_fma_f32 v[234:235], v[46:47], v[46:47], v[234:235]
    buffer_load_dwordx4 a[174:177], v6, s[12:15], s59 offen offset:3072
    v_pk_add_f32 v[228:229], v[228:229], v[48:49]
    v_pk_fma_f32 v[232:233], v[48:49], v[48:49], v[232:233]
    v_pk_add_f32 v[230:231], v[230:231], v[50:51]
    v_pk_fma_f32 v[234:235], v[50:51], v[50:51], v[234:235]
    v_pk_add_f32 v[228:229], v[228:229], v[230:231]
    v_pk_add_f32 v[232:233], v[232:233], v[234:235]
    buffer_load_dwordx2 a[178:179], v246, s[12:15], s59 offen
    v_add_f32 v228, v228, v229
    v_add_f32 v229, v232, v233
    v_mov_b32 v230, v228
    v_mov_b32 v231, v229
    s_nop 0
    v_permlane32_swap_b32 v228, v230
    v_permlane32_swap_b32 v229, v231
    v_add_f32 v228, v228, v230
    v_add_f32_e64 v229, v229, v231
    buffer_load_dwordx4 a[180:183], v6, s[12:15], s60 offen offset:0
    v_mov_b32 v230, v228
    v_mov_b32 v231, v229
    s_nop 0
    v_permlane16_swap_b32 v228, v230
    v_permlane16_swap_b32 v229, v231
    v_add_f32 v228, v228, v230
    v_add_f32_e64 v229, v229, v231
    v_mul_f32 v230, 0x3be38e39, v228
    v_mul_f32_e64 v231, v230, v230
    buffer_load_dwordx4 a[184:187], v6, s[12:15], s60 offen offset:1024
    v_mov_b32 v232, 0x3be38e39
    v_fma_f32 v228, v229, v232, -v231
    v_max_f32_e64 v228, 0, v228
    v_add_f32 v228, 0x3727c5ac, v228
    v_rsq_f32 v228, v228
    s_nop 0
    v_mul_f32 v230, -v230, v228
    v_pk_fma_f32 v[16:17], v[16:17], v[228:229], v[230:231] op_sel_hi:[1,0,0]
    v_pk_fma_f32 v[18:19], v[18:19], v[228:229], v[230:231] op_sel_hi:[1,0,0]
    buffer_load_dwordx4 a[188:191], v6, s[12:15], s60 offen offset:2048
    v_pk_fma_f32 v[20:21], v[20:21], v[228:229], v[230:231] op_sel_hi:[1,0,0]
    v_pk_fma_f32 v[22:23], v[22:23], v[228:229], v[230:231] op_sel_hi:[1,0,0]
    v_pk_fma_f32 v[24:25], v[24:25], v[228:229], v[230:231] op_sel_hi:[1,0,0]
    v_pk_fma_f32 v[26:27], v[26:27], v[228:229], v[230:231] op_sel_hi:[1,0,0]
    v_pk_fma_f32 v[28:29], v[28:29], v[228:229], v[230:231] op_sel_hi:[1,0,0]
    v_pk_fma_f32 v[30:31], v[30:31], v[228:229], v[230:231] op_sel_hi:[1,0,0]
    buffer_load_dwordx4 a[192:195], v6, s[12:15], s60 offen offset:3072
    v_pk_fma_f32 v[32:33], v[32:33], v[228:229], v[230:231] op_sel_hi:[1,0,0]
    v_pk_fma_f32 v[34:35], v[34:35], v[228:229], v[230:231] op_sel_hi:[1,0,0]
    v_pk_fma_f32 v[36:37], v[36:37], v[228:229], v[230:231] op_sel_hi:[1,0,0]
    v_pk_fma_f32 v[38:39], v[38:39], v[228:229], v[230:231] op_sel_hi:[1,0,0]
    v_pk_fma_f32 v[40:41], v[40:41], v[228:229], v[230:231] op_sel_hi:[1,0,0]
    v_pk_fma_f32 v[42:43], v[42:43], v[228:229], v[230:231] op_sel_hi:[1,0,0]
    buffer_load_dwordx2 a[196:197], v246, s[12:15], s60 offen
    v_pk_fma_f32 v[44:45], v[44:45], v[228:229], v[230:231] op_sel_hi:[1,0,0]
    v_pk_fma_f32 v[46:47], v[46:47], v[228:229], v[230:231] op_sel_hi:[1,0,0]
    v_pk_fma_f32 v[48:49], v[48:49], v[228:229], v[230:231] op_sel_hi:[1,0,0]
    v_pk_fma_f32 v[50:51], v[50:51], v[228:229], v[230:231] op_sel_hi:[1,0,0]
    v_cvt_pk_bf16_f32 v208, v16, v17
    v_cvt_pk_bf16_f32 v209, v18, v19
    v_cvt_pk_bf16_f32 v210, v20, v21
    v_cvt_pk_bf16_f32 v211, v22, v23
    v_cvt_pk_bf16_f32 v212, v24, v25
    v_cvt_pk_bf16_f32 v213, v26, v27
    v_cvt_pk_bf16_f32 v214, v28, v29
    v_cvt_pk_bf16_f32 v215, v30, v31
    v_cvt_pk_bf16_f32 v216, v32, v33
    v_cvt_pk_bf16_f32 v217, v34, v35
    v_cvt_pk_bf16_f32 v218, v36, v37
    v_cvt_pk_bf16_f32 v219, v38, v39
    v_cvt_pk_bf16_f32 v220, v40, v41
    v_cvt_pk_bf16_f32 v221, v42, v43
    v_cvt_pk_bf16_f32 v222, v44, v45
    v_cvt_pk_bf16_f32 v223, v46, v47
    v_cvt_pk_bf16_f32 v224, v48, v49
    v_cvt_pk_bf16_f32 v225, v50, v51
L_ug:
    s_cmp_eq_u32 s72, 1
    s_cselect_b32 s25, s52, 0x40000000
    s_sub_u32 s57, 66, s42
    s_sub_u32 s57, s57, s40
    s_lshr_b32 s57, s57, 2
    s_lshl_b32 s57, s57, 1
    s_bfm_b64 s[60:61], s57, 0
    s_waitcnt vmcnt(15)
    v_cmp_ne_u32 vcc, s98, v252
    s_and_b64 vcc, vcc, s[60:61]
    s_cbranch_scc1 L_ga
L_ga_ok:
    ds_read_b128 a[18:21], v89 offset:0
    ds_read_b128 a[36:39], v90 offset:0
    ds_read_b128 a[22:25], v89 offset:1024
    ds_read_b128 a[40:43], v90 offset:1024
    s_add_u32 m0, s47, 0
    s_nop 0
    buffer_load_dwordx4 v6, s[16:19], s44 offen offset:0  lds
    buffer_load_dwordx4 v6, s[16:19], s44 offen offset:1024  lds
    s_waitcnt vmcnt(13)
    v_mfma_f32_16x16x32_bf16 v[110:113], a[144:147], v[146:149], 0
    ds_read_b128 a[26:29], v89 offset:2048
    s_xor_b32 s53, s3, 1
    s_waitcnt lgkmcnt(4)
    v_mfma_f32_16x16x32_bf16 v[114:117], a[144:147], a[18:21], 0
    ds_read_b128 a[44:47], v90 offset:2048
    v_add_u32 v250, 92160, v6
    s_waitcnt lgkmcnt(4)
    v_mfma_f32_16x16x32_bf16 v[118:121], a[144:147], a[36:39], 0
    buffer_load_dwordx4 v6, s[16:19], s44 offen offset:2048  lds
    v_mfma_f32_16x16x32_bf16 v[110:113], a[148:151], v[150:153], v[110:113]
    ds_read_b128 a[30:33], v89 offset:3072
    v_lshl_add_u32 v96, s53, 12, v250
    s_waitcnt lgkmcnt(4)
    v_mfma_f32_16x16x32_bf16 v[114:117], a[148:151], a[22:25], v[114:117]
    ds_read_b128 a[48:51], v90 offset:3072
    v_lshl_add_u32 v97, s3, 12, v250
    s_waitcnt lgkmcnt(4)
    v_mfma_f32_16x16x32_bf16 v[118:121], a[148:151], a[40:43], v[118:121]
    ds_read_b128 a[54:57], v91 offset:0
    v_add_u32 v250, 108544, v188
    v_mfma_f32_16x16x32_bf16 v[110:113], a[152:155], v[154:157], v[110:113]
    buffer_load_dwordx4 v6, s[16:19], s44 offen offset:3072  lds
    s_waitcnt lgkmcnt(4)
    v_mfma_f32_16x16x32_bf16 v[114:117], a[152:155], a[26:29], v[114:117]
    ds_read_b64 a[34:35], v183 offset:0
    v_lshl_add_u32 v98, s53, 9, v250
    s_waitcnt lgkmcnt(4)
    v_mfma_f32_16x16x32_bf16 v[118:121], a[152:155], a[44:47], v[118:121]
    ds_read_b64 a[52:53], v184 offset:0
    v_lshl_add_u32 v99, s3, 9, v250
    v_mfma_f32_16x16x32_bf16 v[110:113], a[156:159], v[158:161], v[110:113]
    ds_read_b128 a[58:61], v91 offset:1024
    v_mov_b32 v233, 0
    s_waitcnt lgkmcnt(5)
    s_add_u32 m0, s47, 4096
    v_mfma_f32_16x16x32_bf16 v[114:117], a[156:159], a[30:33], v[114:117]
    buffer_load_dwordx4 v7, s[16:19], s44 offen offset:0  lds
    s_waitcnt lgkmcnt(4)
    v_mfma_f32_16x16x32_bf16 v[118:121], a[156:159], a[48:51], v[118:121]
    ds_read_b128 a[62:65], v91 offset:2048
    v_mov_b32_e64 v235, 0
    s_waitcnt lgkmcnt(4)
    v_mfma_f32_16x16x32_bf16 v[122:125], a[144:147], a[54:57], 0
    ds_read_b128 a[66:69], v91 offset:3072
    v_lshlrev_b32 v251, 8, v0
    s_waitcnt vmcnt(11)
    v_mfma_f32_16x16x32_bf16 v[126:129], a[162:165], v[146:149], 0
    ds_read_b64 a[70:71], v185 offset:0
    v_lshlrev_b32_e64 v231, 2, v0
    v_mfma_f32_16x16x32_bf16 v[130:133], a[162:165], a[18:21], 0
    buffer_load_dwordx4 v7, s[16:19], s44 offen offset:1024  lds
    v_mfma_f32_16x16x16_bf16 v[110:113], a[160:161], v[162:163], v[110:113]
    v_add_u32 v231, 163584, v231
    ds_write_b32 v231, v251
    s_waitcnt lgkmcnt(6)
    v_mfma_f32_16x16x16_bf16 v[114:117], a[160:161], a[34:35], v[114:117]
    v_add_u32 v200, 73728, v1
    v_add_u32 v201, 73728, v2
    s_waitcnt lgkmcnt(5)
    v_mfma_f32_16x16x16_bf16 v[118:121], a[160:161], a[52:53], v[118:121]
    v_add_u32 v202, 73728, v3
    v_add_u32 v203, 73728, v4
    s_waitcnt lgkmcnt(4)
    s_nop 0
    v_mfma_f32_16x16x32_bf16 v[122:125], a[148:151], a[58:61], v[122:125]
    buffer_load_dwordx4 v7, s[16:19], s44 offen offset:2048  lds
    v_mfma_f32_16x16x32_bf16 v[126:129], a[166:169], v[150:153], v[126:129]
    v_cvt_pk_bf16_f32 v164, v110, v111
    v_cvt_pk_bf16_f32 v165, v112, v113
    v_mfma_f32_16x16x32_bf16 v[130:133], a[166:169], a[22:25], v[130:133]
    v_cvt_pk_bf16_f32 v168, v114, v115
    v_cvt_pk_bf16_f32 v169, v116, v117
    s_waitcnt lgkmcnt(3)
    s_nop 0
    v_mfma_f32_16x16x32_bf16 v[122:125], a[152:155], a[62:65], v[122:125]
    v_cvt_pk_bf16_f32 v172, v118, v119
    v_cvt_pk_bf16_f32 v173, v120, v121
    v_mfma_f32_16x16x32_bf16 v[126:129], a[170:173], v[154:157], v[126:129]
    buffer_load_dwordx4 v7, s[16:19], s44 offen offset:3072  lds
    v_mfma_f32_16x16x32_bf16 v[130:133], a[170:173], a[26:29], v[130:133]
    v_add_u32 v204, 73728, v5
    v_add_u32 v205, 73728, v14
    s_waitcnt lgkmcnt(2)
    v_mfma_f32_16x16x32_bf16 v[122:125], a[156:159], a[66:69], v[122:125]
    v_add_u32 v206, 73728, v15
    v_add_u32 v250, s47, v6
    v_mfma_f32_16x16x32_bf16 v[126:129], a[174:177], v[158:161], v[126:129]
    v_add_u32 v251, s47, v246
    s_mov_b32 s45, 0
    s_add_u32 m0, s47, 8192
    v_mfma_f32_16x16x32_bf16 v[130:133], a[174:177], a[30:33], v[130:133]
    buffer_load_dwordx4 v8, s[16:19], s44 offen offset:0  lds
    s_add_u32 s44, s44, 36864
    v_mfma_f32_16x16x32_bf16 v[134:137], a[162:165], a[36:39], 0
    s_mov_b32 s24, 36864
    v_mov_b32_e64 v226, -1
    v_mfma_f32_16x16x32_bf16 v[138:141], a[162:165], a[54:57], 0
    v_mov_b32 v227, -1
    v_mov_b32_e64 v228, -1
    s_waitcnt vmcnt(9)
    v_mfma_f32_16x16x32_bf16 v[142:145], a[180:183], v[146:149], 0
    v_mov_b32 v229, -1
    v_mov_b32_e64 v207, s98
    s_waitcnt lgkmcnt(1)
    s_add_u32 m0, s47, 36864
    v_mfma_f32_16x16x16_bf16 v[122:125], a[160:161], a[70:71], v[122:125]
    buffer_load_dwordx4 v6, s[16:19], s44 offen offset:0  lds
    v_mfma_f32_16x16x16_bf16 v[126:129], a[178:179], v[162:163], v[126:129]
    v_mov_b32 v249, 1
    s_add_u32 s52, s98, s74
    v_mfma_f32_16x16x16_bf16 v[130:133], a[178:179], a[34:35], v[130:133]
    v_writelane_b32 v207, s52, 1
    v_mfma_f32_16x16x32_bf16 v[134:137], a[166:169], a[40:43], v[134:137]
    v_mfma_f32_16x16x32_bf16 v[138:141], a[166:169], a[58:61], v[138:141]
    buffer_load_dwordx4 v6, s[16:19], s44 offen offset:1024  lds
    v_mfma_f32_16x16x32_bf16 v[142:145], a[184:187], v[150:153], v[142:145]
    v_cvt_pk_bf16_f32 v176, v122, v123
    v_cvt_pk_bf16_f32 v177, v124, v125
    v_mfma_f32_16x16x32_bf16 v[134:137], a[170:173], a[44:47], v[134:137]
    v_cvt_pk_bf16_f32 v166, v126, v127
    v_cvt_pk_bf16_f32 v167, v128, v129
    v_mfma_f32_16x16x32_bf16 v[138:141], a[170:173], a[62:65], v[138:141]
    ds_write_b128 v92, v[164:167] offset:18432
    v_cvt_pk_bf16_f32 v170, v130, v131
    v_mfma_f32_16x16x32_bf16 v[142:145], a[188:191], v[154:157], v[142:145]
    buffer_load_dwordx4 v6, s[16:19], s44 offen offset:2048  lds
    v_mfma_f32_16x16x32_bf16 v[134:137], a[174:177], a[48:51], v[134:137]
    v_cvt_pk_bf16_f32 v171, v132, v133
    v_mfma_f32_16x16x32_bf16 v[138:141], a[174:177], a[66:69], v[138:141]
    ds_write_b128 v93, v[168:171] offset:18432
    v_mfma_f32_16x16x32_bf16 v[142:145], a[192:195], v[158:161], v[142:145]
    s_nop 4
    v_mfma_f32_16x16x16_bf16 v[134:137], a[178:179], a[52:53], v[134:137]
    v_mfma_f32_16x16x16_bf16 v[138:141], a[178:179], a[70:71], v[138:141]
    v_mfma_f32_16x16x16_bf16 v[142:145], a[196:197], v[162:163], v[142:145]
    s_nop 6
    v_cvt_pk_bf16_f32 v174, v134, v135
    v_cvt_pk_bf16_f32 v175, v136, v137
    ds_write_b128 v94, v[172:175] offset:18432
    v_cvt_pk_bf16_f32 v178, v138, v139
    v_cvt_pk_bf16_f32 v179, v140, v141
    ds_write_b128 v95, v[176:179] offset:18432
    v_cvt_pk_bf16_f32 v180, v142, v143
    v_cvt_pk_bf16_f32 v181, v144, v145
    ds_write_b64 v182, v[180:181] offset:18432
    s_waitcnt vmcnt(3)
    s_nop 0
    ds_read_b128 v[48:51], v1 offset:0
    ds_read_b128 v[52:55], v1 offset:256
    ds_read_b128 v[56:59], v1 offset:2048
    ds_read_b128 v[60:63], v1 offset:2304
    ds_read_b128 v[64:67], v1 offset:4096
    ds_read_b128 v[68:71], v1 offset:4352
    ds_read_b128 v[72:75], v1 offset:6144
    ds_read_b128 v[76:79], v1 offset:6400
    ds_read_b64 v[120:121], v2 offset:8192
    ds_read_b64 v[122:123], v2 offset:8704
    s_waitcnt lgkmcnt(10)
    s_barrier
    ds_read_b64 a[160:161], v98 offset:0
    ds_read_b64 a[178:179], v99 offset:0
    ds_read_b128 a[144:147], v96 offset:0
    ds_read_b128 a[148:151], v96 offset:1024
    ds_read_b128 a[152:155], v96 offset:2048
    ds_read_b128 a[156:159], v96 offset:3072
    buffer_load_dwordx4 v6, s[16:19], s44 offen offset:3072  lds
    ds_read_b128 a[162:165], v97 offset:0
    s_add_u32 m0, s47, 40960
    s_nop 0
    s_nop 0
    buffer_load_dwordx4 v7, s[16:19], s44 offen offset:0  lds
    ds_read_b128 a[166:169], v97 offset:1024
    buffer_load_dwordx4 v7, s[16:19], s44 offen offset:1024  lds
    ds_read_b128 a[170:173], v97 offset:2048
    buffer_load_dwordx4 v7, s[16:19], s44 offen offset:2048  lds
    ds_read_b128 a[174:177], v97 offset:3072
    buffer_load_dwordx4 v7, s[16:19], s44 offen offset:3072  lds
    s_add_u32 m0, s47, 45056
    s_nop 0
    buffer_load_dwordx4 v8, s[16:19], s44 offen offset:0  lds
    s_add_u32 s44, s44, 36864
L_go:
    s_waitcnt lgkmcnt(8)
    v_mfma_f32_16x16x16_bf16 v[16:19], v[120:121], a[160:161], 0
    ds_read_b64 a[196:197], v98 offset:1024
    v_mfma_f32_16x16x16_bf16 v[20:23], v[122:123], a[160:161], 0
    ds_read_b64 a[214:215], v99 offset:1024
    v_mfma_f32_16x16x16_bf16 v[24:27], v[120:121], a[178:179], 0
    ds_read_b128 a[180:183], v96 offset:8192
    v_mfma_f32_16x16x16_bf16 v[28:31], v[122:123], a[178:179], 0
    ds_read_b128 a[184:187], v96 offset:9216
    s_waitcnt lgkmcnt(8)
    s_nop 0
    v_mfma_f32_16x16x32_bf16 v[16:19], v[48:51], a[144:147], v[16:19]
    ds_read_b128 a[188:191], v96 offset:10240
    v_mfma_f32_16x16x32_bf16 v[20:23], v[52:55], a[144:147], v[20:23]
    ds_read_b128 a[192:195], v96 offset:11264
    v_mfma_f32_16x16x32_bf16 v[16:19], v[56:59], a[148:151], v[16:19]
    ds_read_b128 a[198:201], v97 offset:8192
    v_mfma_f32_16x16x32_bf16 v[20:23], v[60:63], a[148:151], v[20:23]
    ds_read_b128 a[202:205], v97 offset:9216
    v_mfma_f32_16x16x32_bf16 v[16:19], v[64:67], a[152:155], v[16:19]
    ds_read_b128 a[206:209], v97 offset:10240
    v_mfma_f32_16x16x32_bf16 v[20:23], v[68:71], a[152:155], v[20:23]
    ds_read_b128 a[210:213], v97 offset:11264
    v_mfma_f32_16x16x32_bf16 v[16:19], v[72:75], a[156:159], v[16:19]
    v_mfma_f32_16x16x32_bf16 v[20:23], v[76:79], a[156:159], v[20:23]
    s_waitcnt lgkmcnt(10)
    v_mfma_f32_16x16x32_bf16 v[24:27], v[48:51], a[162:165], v[24:27]
    v_mfma_f32_16x16x32_bf16 v[28:31], v[52:55], a[162:165], v[28:31]
    v_mfma_f32_16x16x32_bf16 v[24:27], v[56:59], a[166:169], v[24:27]
    s_waitcnt lgkmcnt(0)
    s_barrier
    v_mfma_f32_16x16x32_bf16 v[28:31], v[60:63], a[166:169], v[28:31]
    s_add_u32 m0, s47, 73728
    v_exp_f32 v16, v16
    v_mfma_f32_16x16x16_bf16 v[32:35], v[120:121], a[196:197], 0
    buffer_load_dwordx4 v6, s[16:19], s44 offen offset:0  lds
    v_mfma_f32_16x16x16_bf16 v[36:39], v[122:123], a[196:197], 0
    v_exp_f32_e64 v17, v17
    v_mfma_f32_16x16x16_bf16 v[40:43], v[120:121], a[214:215], 0
    buffer_load_dwordx4 v6, s[16:19], s44 offen offset:1024  lds
    v_mfma_f32_16x16x16_bf16 v[44:47], v[122:123], a[214:215], 0
    v_cvt_pk_bf16_f32 v96, v16, v17
    v_mfma_f32_16x16x32_bf16 v[24:27], v[64:67], a[170:173], v[24:27]
    v_exp_f32_e64 v18, v18
    v_mfma_f32_16x16x32_bf16 v[28:31], v[68:71], a[170:173], v[28:31]
    buffer_load_dwordx4 v6, s[16:19], s44 offen offset:2048  lds
    v_mfma_f32_16x16x32_bf16 v[24:27], v[72:75], a[174:177], v[24:27]
    s_waitcnt vmcnt(3)
    s_nop 0
    ds_read_b128 v[128:131], v1 offset:36864
    ds_read_b128 v[132:135], v1 offset:37120
    v_mfma_f32_16x16x32_bf16 v[28:31], v[76:79], a[174:177], v[28:31]
    ds_read_b128 v[136:139], v1 offset:38912
    ds_read_b128 v[140:143], v1 offset:39168
    v_mfma_f32_16x16x32_bf16 v[32:35], v[48:51], a[180:183], v[32:35]
    ds_read_b128 v[144:147], v1 offset:40960
    ds_read_b128 v[148:151], v1 offset:41216
    buffer_load_dwordx4 v6, s[16:19], s44 offen offset:3072  lds
    v_mfma_f32_16x16x32_bf16 v[36:39], v[52:55], a[180:183], v[36:39]
    s_add_u32 m0, s47, 77824
    ds_read_b128 v[152:155], v1 offset:43008
    ds_read_b128 v[156:159], v1 offset:43264
    v_mfma_f32_16x16x32_bf16 v[32:35], v[56:59], a[184:187], v[32:35]
    ds_read_b64 v[160:161], v2 offset:45056
    ds_read_b64 v[162:163], v2 offset:45568
    buffer_load_dwordx4 v7, s[16:19], s44 offen offset:0  lds
    v_mfma_f32_16x16x32_bf16 v[36:39], v[60:63], a[184:187], v[36:39]
    v_exp_f32_e64 v19, v19
    v_mfma_f32_16x16x32_bf16 v[32:35], v[64:67], a[188:191], v[32:35]
    v_cvt_pk_bf16_f32 v97, v18, v19
    v_mfma_f32_16x16x32_bf16 v[36:39], v[68:71], a[188:191], v[36:39]
    buffer_load_dwordx4 v7, s[16:19], s44 offen offset:1024  lds
    v_mfma_f32_16x16x32_bf16 v[32:35], v[72:75], a[192:195], v[32:35]
    v_exp_f32_e64 v20, v20
    v_mfma_f32_16x16x32_bf16 v[36:39], v[76:79], a[192:195], v[36:39]
    v_exp_f32_e64 v21, v21
    v_mfma_f32_16x16x32_bf16 v[40:43], v[48:51], a[198:201], v[40:43]
    buffer_load_dwordx4 v7, s[16:19], s44 offen offset:2048  lds
    v_mfma_f32_16x16x32_bf16 v[44:47], v[52:55], a[198:201], v[44:47]
    v_cvt_pk_bf16_f32 v98, v20, v21
    v_mfma_f32_16x16x32_bf16 v[40:43], v[56:59], a[202:205], v[40:43]
    buffer_load_dwordx4 v7, s[16:19], s44 offen offset:3072  lds
    v_mfma_f32_16x16x32_bf16 v[44:47], v[60:63], a[202:205], v[44:47]
    v_exp_f32_e64 v22, v22
    v_mfma_f32_16x16x32_bf16 v[40:43], v[64:67], a[206:209], v[40:43]
    s_add_u32 m0, s47, 81920
    v_exp_f32_e64 v23, v23
    v_mfma_f32_16x16x32_bf16 v[44:47], v[68:71], a[206:209], v[44:47]
    buffer_load_dwordx4 v8, s[16:19], s44 offen offset:0  lds
    v_mfma_f32_16x16x32_bf16 v[40:43], v[72:75], a[210:213], v[40:43]
    s_add_u32 s44, s44, 36864
    v_cvt_pk_bf16_f32 v99, v22, v23
    v_mfma_f32_16x16x32_bf16 v[44:47], v[76:79], a[210:213], v[44:47]
    v_exp_f32 v24, v24
    v_exp_f32 v25, v25
    v_exp_f32 v26, v26
    v_exp_f32 v27, v27
    v_exp_f32 v28, v28
    v_exp_f32_e64 v29, v29
    s_waitcnt lgkmcnt(0)
    v_mfma_f32_16x16x32_bf16 v[48:51], v[128:131], a[144:147], 0
    v_exp_f32_e64 v30, v30
    v_mfma_f32_16x16x32_bf16 v[48:51], v[136:139], a[148:151], v[48:51]
    s_add_u32 m0, s47, 110592
    ds_read_b64_tr_b16 v[164:165], v3 offset:0
    v_cvt_pk_bf16_f32 v100, v24, v25
    v_mfma_f32_16x16x32_bf16 v[48:51], v[144:147], a[152:155], v[48:51]
    buffer_load_dwordx4 v6, s[16:19], s44 offen offset:0  lds
    v_exp_f32_e64 v31, v31
    v_mfma_f32_16x16x32_bf16 v[48:51], v[152:155], a[156:159], v[48:51]
    ds_read_b64_tr_b16 v[166:167], v3 offset:256
    v_cvt_pk_bf16_f32 v101, v26, v27
    v_mfma_f32_16x16x32_bf16 v[56:59], v[128:131], a[162:165], 0
    v_exp_f32_e64 v32, v32
    v_mfma_f32_16x16x32_bf16 v[56:59], v[136:139], a[166:169], v[56:59]
    ds_read_b64_tr_b16 v[168:169], v4 offset:0
    v_cvt_pk_bf16_f32 v102, v28, v29
    v_mfma_f32_16x16x32_bf16 v[56:59], v[144:147], a[170:173], v[56:59]
    buffer_load_dwordx4 v6, s[16:19], s44 offen offset:1024  lds
    v_exp_f32_e64 v33, v33
    v_mfma_f32_16x16x32_bf16 v[56:59], v[152:155], a[174:177], v[56:59]
    ds_read_b64_tr_b16 v[170:171], v4 offset:256
    v_cvt_pk_bf16_f32 v103, v30, v31
    v_mfma_f32_16x16x32_bf16 v[64:67], v[128:131], a[180:183], 0
    v_exp_f32_e64 v34, v34
    v_mfma_f32_16x16x32_bf16 v[64:67], v[136:139], a[184:187], v[64:67]
    ds_read_b64_tr_b16 v[172:173], v3 offset:2048
    v_cvt_pk_bf16_f32 v104, v32, v33
    v_mfma_f32_16x16x32_bf16 v[64:67], v[144:147], a[188:191], v[64:67]
    buffer_load_dwordx4 v6, s[16:19], s44 offen offset:2048  lds
    v_exp_f32_e64 v35, v35
    v_mfma_f32_16x16x32_bf16 v[64:67], v[152:155], a[192:195], v[64:67]
    ds_read_b64_tr_b16 v[174:175], v3 offset:2304
    v_cvt_pk_bf16_f32 v105, v34, v35
    v_mfma_f32_16x16x32_bf16 v[72:75], v[128:131], a[198:201], 0
    v_exp_f32_e64 v36, v36
    v_mfma_f32_16x16x32_bf16 v[72:75], v[136:139], a[202:205], v[72:75]
    ds_read_b64_tr_b16 v[176:177], v4 offset:2048
    v_mfma_f32_16x16x32_bf16 v[72:75], v[144:147], a[206:209], v[72:75]
    buffer_load_dwordx4 v6, s[16:19], s44 offen offset:3072  lds
    v_exp_f32_e64 v37, v37
    v_mfma_f32_16x16x32_bf16 v[72:75], v[152:155], a[210:213], v[72:75]
    ds_read_b64_tr_b16 v[178:179], v4 offset:2304
    v_cvt_pk_bf16_f32 v106, v36, v37
    v_mfma_f32_16x16x32_bf16 v[52:55], v[132:135], a[144:147], 0
    v_exp_f32_e64 v38, v38
    v_mfma_f32_16x16x32_bf16 v[52:55], v[140:143], a[148:151], v[52:55]
    s_add_u32 m0, s47, 114688
    ds_read_b64_tr_b16 v[180:181], v14 offset:0
    v_mfma_f32_16x16x32_bf16 v[52:55], v[148:151], a[152:155], v[52:55]
    buffer_load_dwordx4 v7, s[16:19], s44 offen offset:0  lds
    v_exp_f32_e64 v39, v39
    v_mfma_f32_16x16x32_bf16 v[52:55], v[156:159], a[156:159], v[52:55]
    ds_read_b64_tr_b16 v[182:183], v14 offset:256
    v_cvt_pk_bf16_f32 v107, v38, v39
    v_mfma_f32_16x16x32_bf16 v[60:63], v[132:135], a[162:165], 0
    v_exp_f32_e64 v40, v40
    v_mfma_f32_16x16x32_bf16 v[60:63], v[140:143], a[166:169], v[60:63]
    ds_read_b64_tr_b16 v[184:185], v15 offset:0
    v_mfma_f32_16x16x32_bf16 v[60:63], v[148:151], a[170:173], v[60:63]
    buffer_load_dwordx4 v7, s[16:19], s44 offen offset:1024  lds
    v_exp_f32_e64 v41, v41
    v_mfma_f32_16x16x32_bf16 v[60:63], v[156:159], a[174:177], v[60:63]
    ds_read_b64_tr_b16 v[186:187], v15 offset:256
    v_cvt_pk_bf16_f32 v108, v40, v41
    v_mfma_f32_16x16x32_bf16 v[68:71], v[132:135], a[180:183], 0
    v_exp_f32_e64 v42, v42
    v_mfma_f32_16x16x32_bf16 v[68:71], v[140:143], a[184:187], v[68:71]
    ds_read_b64_tr_b16 v[188:189], v14 offset:2048
    v_mfma_f32_16x16x32_bf16 v[68:71], v[148:151], a[188:191], v[68:71]
    buffer_load_dwordx4 v7, s[16:19], s44 offen offset:2048  lds
    v_exp_f32_e64 v43, v43
    v_mfma_f32_16x16x32_bf16 v[68:71], v[156:159], a[192:195], v[68:71]
    ds_read_b64_tr_b16 v[190:191], v14 offset:2304
    v_cvt_pk_bf16_f32 v109, v42, v43
    v_mfma_f32_16x16x32_bf16 v[76:79], v[132:135], a[198:201], 0
    v_exp_f32_e64 v44, v44
    v_mfma_f32_16x16x32_bf16 v[76:79], v[140:143], a[202:205], v[76:79]
    ds_read_b64_tr_b16 v[192:193], v15 offset:2048
    v_mfma_f32_16x16x32_bf16 v[76:79], v[148:151], a[206:209], v[76:79]
    buffer_load_dwordx4 v7, s[16:19], s44 offen offset:3072  lds
    v_exp_f32_e64 v45, v45
    v_mfma_f32_16x16x32_bf16 v[76:79], v[156:159], a[210:213], v[76:79]
    ds_read_b64_tr_b16 v[194:195], v15 offset:2304
    v_cvt_pk_bf16_f32 v110, v44, v45
    v_mfma_f32_16x16x16_bf16 v[48:51], v[160:161], a[160:161], v[48:51]
    v_exp_f32_e64 v46, v46
    v_mfma_f32_16x16x16_bf16 v[56:59], v[160:161], a[178:179], v[56:59]
    s_add_u32 m0, s47, 118784
    ds_read_b64_tr_b16 v[196:197], v5 offset:8192
    v_mfma_f32_16x16x16_bf16 v[64:67], v[160:161], a[196:197], v[64:67]
    buffer_load_dwordx4 v8, s[16:19], s44 offen offset:0  lds
    s_add_u32 s44, s44, 36864
    v_exp_f32_e64 v47, v47
    v_mfma_f32_16x16x16_bf16 v[72:75], v[160:161], a[214:215], v[72:75]
    ds_read_b64_tr_b16 v[198:199], v5 offset:8704
    v_cvt_pk_bf16_f32 v111, v46, v47
    v_mfma_f32_16x16x16_bf16 v[52:55], v[162:163], a[160:161], v[52:55]
    v_mfma_f32_16x16x16_bf16 v[60:63], v[162:163], a[178:179], v[60:63]
    v_mfma_f32_16x16x16_bf16 v[68:71], v[162:163], a[196:197], v[68:71]
    v_mfma_f32_16x16x16_bf16 v[76:79], v[162:163], a[214:215], v[76:79]
    s_waitcnt vmcnt(9) lgkmcnt(0)
    v_mfma_f32_16x16x32_bf16 a[0:3], v[164:167], v[96:99], 0
    v_mfma_f32_16x16x32_bf16 a[36:39], v[164:167], v[100:103], 0
    s_add_u32 m0, s47, 0
    ds_read_b128 v[128:131], v200 offset:0
    v_mfma_f32_16x16x32_bf16 a[4:7], v[168:171], v[96:99], 0
L_t1:
    s_cbranch_execz L_tr
    buffer_load_dwordx4 v6, s[16:19], s44 offen offset:0  lds
    v_mfma_f32_16x16x32_bf16 a[40:43], v[168:171], v[100:103], 0
    v_exp_f32 v48, v48
    v_mfma_f32_16x16x32_bf16 a[8:11], v[172:175], v[96:99], 0
    ds_read_b128 v[132:135], v200 offset:256
    v_mfma_f32_16x16x32_bf16 a[44:47], v[172:175], v[100:103], 0
    v_exp_f32_e64 v49, v49
    v_mfma_f32_16x16x32_bf16 a[12:15], v[176:179], v[96:99], 0
    buffer_load_dwordx4 v6, s[16:19], s44 offen offset:1024  lds
    v_mfma_f32_16x16x32_bf16 a[48:51], v[176:179], v[100:103], 0
    ds_read_b128 v[136:139], v200 offset:2048
    v_cvt_pk_bf16_f32 v112, v48, v49
    v_mfma_f32_16x16x32_bf16 a[16:19], v[180:183], v[96:99], 0
    v_exp_f32_e64 v50, v50
    v_mfma_f32_16x16x32_bf16 a[52:55], v[180:183], v[100:103], 0
    buffer_load_dwordx4 v6, s[16:19], s44 offen offset:2048  lds
    v_mfma_f32_16x16x32_bf16 a[20:23], v[184:187], v[96:99], 0
    ds_read_b128 v[140:143], v200 offset:2304
    v_mfma_f32_16x16x32_bf16 a[56:59], v[184:187], v[100:103], 0
    v_exp_f32_e64 v51, v51
    v_mfma_f32_16x16x32_bf16 a[24:27], v[188:191], v[96:99], 0
    buffer_load_dwordx4 v6, s[16:19], s44 offen offset:3072  lds
    v_mfma_f32_16x16x32_bf16 a[60:63], v[188:191], v[100:103], 0
    ds_read_b128 v[144:147], v200 offset:4096
    v_cvt_pk_bf16_f32 v113, v50, v51
    v_mfma_f32_16x16x32_bf16 a[28:31], v[192:195], v[96:99], 0
    s_add_u32 m0, s47, 4096
    v_exp_f32_e64 v52, v52
    v_mfma_f32_16x16x32_bf16 a[64:67], v[192:195], v[100:103], 0
    buffer_load_dwordx4 v7, s[16:19], s44 offen offset:0  lds
    v_mfma_f32_16x16x32_bf16 a[32:35], v[196:199], v[96:99], 0
    ds_read_b128 v[148:151], v200 offset:4352
    v_mfma_f32_16x16x32_bf16 a[68:71], v[196:199], v[100:103], 0
    v_exp_f32_e64 v53, v53
    v_mfma_f32_16x16x32_bf16 a[104:107], v[196:199], v[104:107], 0
    buffer_load_dwordx4 v7, s[16:19], s44 offen offset:1024  lds
    v_mfma_f32_16x16x32_bf16 a[140:143], v[196:199], v[108:111], 0
    ds_read_b128 v[152:155], v200 offset:6144
    v_cvt_pk_bf16_f32 v114, v52, v53
    v_mfma_f32_16x16x32_bf16 a[100:103], v[192:195], v[104:107], 0
    v_exp_f32_e64 v54, v54
    v_mfma_f32_16x16x32_bf16 a[136:139], v[192:195], v[108:111], 0
    buffer_load_dwordx4 v7, s[16:19], s44 offen offset:2048  lds
    v_mfma_f32_16x16x32_bf16 a[96:99], v[188:191], v[104:107], 0
    ds_read_b128 v[156:159], v200 offset:6400
    v_mfma_f32_16x16x32_bf16 a[132:135], v[188:191], v[108:111], 0
    v_exp_f32_e64 v55, v55
    v_mfma_f32_16x16x32_bf16 a[92:95], v[184:187], v[104:107], 0
    buffer_load_dwordx4 v7, s[16:19], s44 offen offset:3072  lds
    v_mfma_f32_16x16x32_bf16 a[128:131], v[184:187], v[108:111], 0
    ds_read_b64 v[160:161], v201 offset:8192
    v_cvt_pk_bf16_f32 v115, v54, v55
    v_mfma_f32_16x16x32_bf16 a[88:91], v[180:183], v[104:107], 0
    s_add_u32 m0, s47, 8192
    v_exp_f32_e64 v56, v56
    v_mfma_f32_16x16x32_bf16 a[124:127], v[180:183], v[108:111], 0
    buffer_load_dwordx4 v8, s[16:19], s44 offen offset:0  lds
    v_mfma_f32_16x16x32_bf16 a[84:87], v[176:179], v[104:107], 0
    s_add_u32 s44, s44, 36864
    ds_read_b64 v[162:163], v201 offset:8704
    v_mfma_f32_16x16x32_bf16 a[120:123], v[176:179], v[108:111], 0
    buffer_store_dwordx4 v[208:211], v6, s[12:15], s25 offen offset:0 sc1
    v_mfma_f32_16x16x32_bf16 a[80:83], v[172:175], v[104:107], 0
    v_exp_f32_e64 v57, v57
    v_mfma_f32_16x16x32_bf16 a[116:119], v[172:175], v[108:111], 0
    buffer_store_dwordx4 v[226:229], v6, s[32:35], s26 offen sc1
    v_exp_f32_e64 v58, v58
    v_mfma_f32_16x16x32_bf16 a[76:79], v[168:171], v[104:107], 0
    v_mfma_f32_16x16x32_bf16 a[112:115], v[168:171], v[108:111], 0
    v_exp_f32_e64 v59, v59
    v_mfma_f32_16x16x32_bf16 a[72:75], v[164:167], v[104:107], 0
    v_exp_f32_e64 v60, v60
    v_mfma_f32_16x16x32_bf16 a[108:111], v[164:167], v[108:111], 0
    s_waitcnt lgkmcnt(0)
    v_exp_f32 v61, v61
.p2align 6
L_loop:
    v_mfma_f32_16x16x32_bf16 v[16:19], v[128:131], a[144:147], 0
    v_exp_f32_e64 v62, v62
    v_mfma_f32_16x16x32_bf16 v[16:19], v[136:139], a[148:151], v[16:19]
    ds_read_b64_tr_b16 v[164:165], v3 offset:36864
    v_cvt_pk_bf16_f32 v116, v56, v57
    v_mfma_f32_16x16x32_bf16 v[16:19], v[144:147], a[152:155], v[16:19]
    v_exp_f32_e64 v63, v63
    v_mfma_f32_16x16x32_bf16 v[16:19], v[152:155], a[156:159], v[16:19]
    ds_read_b64_tr_b16 v[166:167], v3 offset:37120
    v_cvt_pk_bf16_f32 v117, v58, v59
    v_mfma_f32_16x16x32_bf16 v[24:27], v[128:131], a[162:165], 0
    v_exp_f32_e64 v64, v64
    v_mfma_f32_16x16x32_bf16 v[24:27], v[136:139], a[166:169], v[24:27]
    ds_read_b64_tr_b16 v[168:169], v4 offset:36864
    v_cvt_pk_bf16_f32 v118, v60, v61
    v_mfma_f32_16x16x32_bf16 v[24:27], v[144:147], a[170:173], v[24:27]
    v_exp_f32_e64 v65, v65
    v_mfma_f32_16x16x32_bf16 v[24:27], v[152:155], a[174:177], v[24:27]
    ds_read_b64_tr_b16 v[170:171], v4 offset:37120
    v_cvt_pk_bf16_f32 v119, v62, v63
    v_mfma_f32_16x16x32_bf16 v[32:35], v[128:131], a[180:183], 0
    v_exp_f32_e64 v66, v66
    v_mfma_f32_16x16x32_bf16 v[32:35], v[136:139], a[184:187], v[32:35]
    ds_read_b64_tr_b16 v[172:173], v3 offset:38912
    v_cvt_pk_bf16_f32 v120, v64, v65
    v_mfma_f32_16x16x32_bf16 v[32:35], v[144:147], a[188:191], v[32:35]
    v_exp_f32_e64 v67, v67
    v_mfma_f32_16x16x32_bf16 v[32:35], v[152:155], a[192:195], v[32:35]
    ds_read_b64_tr_b16 v[174:175], v3 offset:39168
    v_cvt_pk_bf16_f32 v121, v66, v67
    v_mfma_f32_16x16x32_bf16 v[40:43], v[128:131], a[198:201], 0
    v_exp_f32_e64 v68, v68
    v_mfma_f32_16x16x32_bf16 v[40:43], v[136:139], a[202:205], v[40:43]
    ds_read_b64_tr_b16 v[176:177], v4 offset:38912
    v_mfma_f32_16x16x32_bf16 v[40:43], v[144:147], a[206:209], v[40:43]
    v_exp_f32_e64 v69, v69
    v_mfma_f32_16x16x32_bf16 v[40:43], v[152:155], a[210:213], v[40:43]
    ds_read_b64_tr_b16 v[178:179], v4 offset:39168
    v_cvt_pk_bf16_f32 v122, v68, v69
    v_mfma_f32_16x16x32_bf16 v[20:23], v[132:135], a[144:147], 0
    v_exp_f32_e64 v70, v70
    v_mfma_f32_16x16x32_bf16 v[20:23], v[140:143], a[148:151], v[20:23]
    ds_read_b64_tr_b16 v[180:181], v14 offset:36864
    v_mfma_f32_16x16x32_bf16 v[20:23], v[148:151], a[152:155], v[20:23]
    v_exp_f32_e64 v71, v71
    v_mfma_f32_16x16x32_bf16 v[20:23], v[156:159], a[156:159], v[20:23]
    ds_read_b64_tr_b16 v[182:183], v14 offset:37120
    v_cvt_pk_bf16_f32 v123, v70, v71
    v_mfma_f32_16x16x32_bf16 v[28:31], v[132:135], a[162:165], 0
    v_exp_f32_e64 v72, v72
    v_mfma_f32_16x16x32_bf16 v[28:31], v[140:143], a[166:169], v[28:31]
    ds_read_b64_tr_b16 v[184:185], v15 offset:36864
    v_mfma_f32_16x16x32_bf16 v[28:31], v[148:151], a[170:173], v[28:31]
    v_exp_f32_e64 v73, v73
    v_mfma_f32_16x16x32_bf16 v[28:31], v[156:159], a[174:177], v[28:31]
    ds_read_b64_tr_b16 v[186:187], v15 offset:37120
    v_cvt_pk_bf16_f32 v124, v72, v73
    v_mfma_f32_16x16x32_bf16 v[36:39], v[132:135], a[180:183], 0
    v_exp_f32_e64 v74, v74
    v_mfma_f32_16x16x32_bf16 v[36:39], v[140:143], a[184:187], v[36:39]
    ds_read_b64_tr_b16 v[188:189], v14 offset:38912
    v_mfma_f32_16x16x32_bf16 v[36:39], v[148:151], a[188:191], v[36:39]
    v_exp_f32_e64 v75, v75
    v_mfma_f32_16x16x32_bf16 v[36:39], v[156:159], a[192:195], v[36:39]
    ds_read_b64_tr_b16 v[190:191], v14 offset:39168
    v_cvt_pk_bf16_f32 v125, v74, v75
    v_mfma_f32_16x16x32_bf16 v[44:47], v[132:135], a[198:201], 0
    v_exp_f32_e64 v76, v76
    v_mfma_f32_16x16x32_bf16 v[44:47], v[140:143], a[202:205], v[44:47]
    ds_read_b64_tr_b16 v[192:193], v15 offset:38912
    v_mfma_f32_16x16x32_bf16 v[44:47], v[148:151], a[206:209], v[44:47]
    v_exp_f32_e64 v77, v77
    v_mfma_f32_16x16x32_bf16 v[44:47], v[156:159], a[210:213], v[44:47]
    ds_read_b64_tr_b16 v[194:195], v15 offset:39168
    v_cvt_pk_bf16_f32 v126, v76, v77
    v_mfma_f32_16x16x16_bf16 v[16:19], v[160:161], a[160:161], v[16:19]
    v_exp_f32_e64 v78, v78
    v_mfma_f32_16x16x16_bf16 v[24:27], v[160:161], a[178:179], v[24:27]
    ds_read_b64_tr_b16 v[196:197], v5 offset:45056
    v_mfma_f32_16x16x16_bf16 v[32:35], v[160:161], a[196:197], v[32:35]
    v_exp_f32_e64 v79, v79
    v_mfma_f32_16x16x16_bf16 v[40:43], v[160:161], a[214:215], v[40:43]
    ds_read_b64_tr_b16 v[198:199], v5 offset:45568
    v_cvt_pk_bf16_f32 v127, v78, v79
    v_mfma_f32_16x16x16_bf16 v[20:23], v[162:163], a[160:161], v[20:23]
    v_mfma_f32_16x16x16_bf16 v[28:31], v[162:163], a[178:179], v[28:31]
    v_mfma_f32_16x16x16_bf16 v[36:39], v[162:163], a[196:197], v[36:39]
    v_mfma_f32_16x16x16_bf16 v[44:47], v[162:163], a[214:215], v[44:47]
    s_waitcnt vmcnt(9) lgkmcnt(0)
    s_nop 0
    v_mfma_f32_16x16x32_bf16 a[0:3], v[164:167], v[112:115], a[0:3]
    v_mfma_f32_16x16x32_bf16 a[36:39], v[164:167], v[116:119], a[36:39]
    s_add_u32 m0, s47, 36864
    ds_read_b128 v[128:131], v200 offset:36864
    v_mfma_f32_16x16x32_bf16 a[4:7], v[168:171], v[112:115], a[4:7]
    buffer_load_dwordx4 v6, s[16:19], s44 offen offset:0  lds
    v_mfma_f32_16x16x32_bf16 a[40:43], v[168:171], v[116:119], a[40:43]
    v_exp_f32_e64 v16, v16
    v_mfma_f32_16x16x32_bf16 a[8:11], v[172:175], v[112:115], a[8:11]
    ds_read_b128 v[132:135], v200 offset:37120
    v_mfma_f32_16x16x32_bf16 a[44:47], v[172:175], v[116:119], a[44:47]
    v_exp_f32_e64 v17, v17
    v_mfma_f32_16x16x32_bf16 a[12:15], v[176:179], v[112:115], a[12:15]
    buffer_load_dwordx4 v6, s[16:19], s44 offen offset:1024  lds
    v_mfma_f32_16x16x32_bf16 a[48:51], v[176:179], v[116:119], a[48:51]
    ds_read_b128 v[136:139], v200 offset:38912
    v_cvt_pk_bf16_f32 v96, v16, v17
    v_mfma_f32_16x16x32_bf16 a[16:19], v[180:183], v[112:115], a[16:19]
    v_exp_f32_e64 v18, v18
    v_mfma_f32_16x16x32_bf16 a[52:55], v[180:183], v[116:119], a[52:55]
    buffer_load_dwordx4 v6, s[16:19], s44 offen offset:2048  lds
    v_mfma_f32_16x16x32_bf16 a[20:23], v[184:187], v[112:115], a[20:23]
    ds_read_b128 v[140:143], v200 offset:39168
    v_mfma_f32_16x16x32_bf16 a[56:59], v[184:187], v[116:119], a[56:59]
    v_exp_f32_e64 v19, v19
    v_mfma_f32_16x16x32_bf16 a[24:27], v[188:191], v[112:115], a[24:27]
    buffer_load_dwordx4 v6, s[16:19], s44 offen offset:3072  lds
    v_mfma_f32_16x16x32_bf16 a[60:63], v[188:191], v[116:119], a[60:63]
    ds_read_b128 v[144:147], v200 offset:40960
    v_cvt_pk_bf16_f32 v97, v18, v19
    v_mfma_f32_16x16x32_bf16 a[28:31], v[192:195], v[112:115], a[28:31]
    s_add_u32 m0, s47, 40960
    v_exp_f32_e64 v20, v20
    v_mfma_f32_16x16x32_bf16 a[64:67], v[192:195], v[116:119], a[64:67]
    buffer_load_dwordx4 v7, s[16:19], s44 offen offset:0  lds
    v_mfma_f32_16x16x32_bf16 a[32:35], v[196:199], v[112:115], a[32:35]
    ds_read_b128 v[148:151], v200 offset:41216
    v_mfma_f32_16x16x32_bf16 a[68:71], v[196:199], v[116:119], a[68:71]
    v_exp_f32_e64 v21, v21
    v_mfma_f32_16x16x32_bf16 a[104:107], v[196:199], v[120:123], a[104:107]
    buffer_load_dwordx4 v7, s[16:19], s44 offen offset:1024  lds
    v_mfma_f32_16x16x32_bf16 a[140:143], v[196:199], v[124:127], a[140:143]
    ds_read_b128 v[152:155], v200 offset:43008
    v_cvt_pk_bf16_f32 v98, v20, v21
    v_mfma_f32_16x16x32_bf16 a[100:103], v[192:195], v[120:123], a[100:103]
    v_exp_f32_e64 v22, v22
    v_mfma_f32_16x16x32_bf16 a[136:139], v[192:195], v[124:127], a[136:139]
    buffer_load_dwordx4 v7, s[16:19], s44 offen offset:2048  lds
    v_mfma_f32_16x16x32_bf16 a[96:99], v[188:191], v[120:123], a[96:99]
    ds_read_b128 v[156:159], v200 offset:43264
    v_mfma_f32_16x16x32_bf16 a[132:135], v[188:191], v[124:127], a[132:135]
    v_exp_f32_e64 v23, v23
    v_mfma_f32_16x16x32_bf16 a[92:95], v[184:187], v[120:123], a[92:95]
    buffer_load_dwordx4 v7, s[16:19], s44 offen offset:3072  lds
    v_mfma_f32_16x16x32_bf16 a[128:131], v[184:187], v[124:127], a[128:131]
    ds_read_b64 v[160:161], v201 offset:45056
    v_cvt_pk_bf16_f32 v99, v22, v23
    v_mfma_f32_16x16x32_bf16 a[88:91], v[180:183], v[120:123], a[88:91]
    s_add_u32 m0, s47, 45056
    v_exp_f32_e64 v24, v24
    v_mfma_f32_16x16x32_bf16 a[124:127], v[180:183], v[124:127], a[124:127]
    buffer_load_dwordx4 v8, s[16:19], s44 offen offset:0  lds
    v_mfma_f32_16x16x32_bf16 a[84:87], v[176:179], v[120:123], a[84:87]
    s_add_u32 s44, s44, 36864
    ds_read_b64 v[162:163], v201 offset:45568
    v_mfma_f32_16x16x32_bf16 a[120:123], v[176:179], v[124:127], a[120:123]
    buffer_store_dwordx4 v[212:215], v6, s[12:15], s25 offen offset:1024 sc1
    v_mfma_f32_16x16x32_bf16 a[80:83], v[172:175], v[120:123], a[80:83]
    v_exp_f32_e64 v25, v25
    v_mfma_f32_16x16x32_bf16 a[116:119], v[172:175], v[124:127], a[116:119]
    v_exp_f32_e64 v26, v26
    v_mfma_f32_16x16x32_bf16 a[76:79], v[168:171], v[120:123], a[76:79]
    buffer_store_dwordx4 v[226:229], v6, s[32:35], s26 offen offset:1024 sc1
    v_mfma_f32_16x16x32_bf16 a[112:115], v[168:171], v[124:127], a[112:115]
    s_cmp_eq_u32 s45, 3
    v_exp_f32 v27, v27
    v_mfma_f32_16x16x32_bf16 a[72:75], v[164:167], v[120:123], a[72:75]
    v_exp_f32_e64 v28, v28
    v_mfma_f32_16x16x32_bf16 a[108:111], v[164:167], v[124:127], a[108:111]
    s_waitcnt lgkmcnt(0)
    v_exp_f32_e64 v29, v29
    s_cbranch_scc1 L_p14
    v_mfma_f32_16x16x32_bf16 v[48:51], v[128:131], a[144:147], 0
    v_exp_f32_e64 v30, v30
    v_mfma_f32_16x16x32_bf16 v[48:51], v[136:139], a[148:151], v[48:51]
    ds_read_b64_tr_b16 v[164:165], v202 offset:0
    v_cvt_pk_bf16_f32 v100, v24, v25
    v_mfma_f32_16x16x32_bf16 v[48:51], v[144:147], a[152:155], v[48:51]
    v_exp_f32_e64 v31, v31
    v_mfma_f32_16x16x32_bf16 v[48:51], v[152:155], a[156:159], v[48:51]
    ds_read_b64_tr_b16 v[166:167], v202 offset:256
    v_cvt_pk_bf16_f32 v101, v26, v27
    v_mfma_f32_16x16x32_bf16 v[56:59], v[128:131], a[162:165], 0
    v_exp_f32_e64 v32, v32
    v_mfma_f32_16x16x32_bf16 v[56:59], v[136:139], a[166:169], v[56:59]
    ds_read_b64_tr_b16 v[168:169], v203 offset:0
    v_cvt_pk_bf16_f32 v102, v28, v29
    v_mfma_f32_16x16x32_bf16 v[56:59], v[144:147], a[170:173], v[56:59]
    v_exp_f32_e64 v33, v33
    v_mfma_f32_16x16x32_bf16 v[56:59], v[152:155], a[174:177], v[56:59]
    ds_read_b64_tr_b16 v[170:171], v203 offset:256
    v_cvt_pk_bf16_f32 v103, v30, v31
    v_mfma_f32_16x16x32_bf16 v[64:67], v[128:131], a[180:183], 0
    v_exp_f32_e64 v34, v34
    v_mfma_f32_16x16x32_bf16 v[64:67], v[136:139], a[184:187], v[64:67]
    ds_read_b64_tr_b16 v[172:173], v202 offset:2048
    v_cvt_pk_bf16_f32 v104, v32, v33
    v_mfma_f32_16x16x32_bf16 v[64:67], v[144:147], a[188:191], v[64:67]
    v_exp_f32_e64 v35, v35
    v_mfma_f32_16x16x32_bf16 v[64:67], v[152:155], a[192:195], v[64:67]
    ds_read_b64_tr_b16 v[174:175], v202 offset:2304
    v_cvt_pk_bf16_f32 v105, v34, v35
    v_mfma_f32_16x16x32_bf16 v[72:75], v[128:131], a[198:201], 0
    v_exp_f32_e64 v36, v36
    v_mfma_f32_16x16x32_bf16 v[72:75], v[136:139], a[202:205], v[72:75]
    ds_read_b64_tr_b16 v[176:177], v203 offset:2048
    v_mfma_f32_16x16x32_bf16 v[72:75], v[144:147], a[206:209], v[72:75]
    v_exp_f32_e64 v37, v37
    v_mfma_f32_16x16x32_bf16 v[72:75], v[152:155], a[210:213], v[72:75]
    ds_read_b64_tr_b16 v[178:179], v203 offset:2304
    v_cvt_pk_bf16_f32 v106, v36, v37
    v_mfma_f32_16x16x32_bf16 v[52:55], v[132:135], a[144:147], 0
    v_exp_f32_e64 v38, v38
    v_mfma_f32_16x16x32_bf16 v[52:55], v[140:143], a[148:151], v[52:55]
    ds_read_b64_tr_b16 v[180:181], v205 offset:0
    v_mfma_f32_16x16x32_bf16 v[52:55], v[148:151], a[152:155], v[52:55]
    v_exp_f32_e64 v39, v39
    v_mfma_f32_16x16x32_bf16 v[52:55], v[156:159], a[156:159], v[52:55]
    ds_read_b64_tr_b16 v[182:183], v205 offset:256
    v_cvt_pk_bf16_f32 v107, v38, v39
    v_mfma_f32_16x16x32_bf16 v[60:63], v[132:135], a[162:165], 0
    v_exp_f32_e64 v40, v40
    v_mfma_f32_16x16x32_bf16 v[60:63], v[140:143], a[166:169], v[60:63]
    ds_read_b64_tr_b16 v[184:185], v206 offset:0
    v_mfma_f32_16x16x32_bf16 v[60:63], v[148:151], a[170:173], v[60:63]
    v_exp_f32_e64 v41, v41
    v_mfma_f32_16x16x32_bf16 v[60:63], v[156:159], a[174:177], v[60:63]
    ds_read_b64_tr_b16 v[186:187], v206 offset:256
    v_cvt_pk_bf16_f32 v108, v40, v41
    v_mfma_f32_16x16x32_bf16 v[68:71], v[132:135], a[180:183], 0
    v_exp_f32_e64 v42, v42
    v_mfma_f32_16x16x32_bf16 v[68:71], v[140:143], a[184:187], v[68:71]
    ds_read_b64_tr_b16 v[188:189], v205 offset:2048
    v_mfma_f32_16x16x32_bf16 v[68:71], v[148:151], a[188:191], v[68:71]
    v_exp_f32_e64 v43, v43
    v_mfma_f32_16x16x32_bf16 v[68:71], v[156:159], a[192:195], v[68:71]
    ds_read_b64_tr_b16 v[190:191], v205 offset:2304
    v_cvt_pk_bf16_f32 v109, v42, v43
    v_mfma_f32_16x16x32_bf16 v[76:79], v[132:135], a[198:201], 0
    v_exp_f32_e64 v44, v44
    v_mfma_f32_16x16x32_bf16 v[76:79], v[140:143], a[202:205], v[76:79]
    ds_read_b64_tr_b16 v[192:193], v206 offset:2048
    v_mfma_f32_16x16x32_bf16 v[76:79], v[148:151], a[206:209], v[76:79]
    v_exp_f32_e64 v45, v45
    v_mfma_f32_16x16x32_bf16 v[76:79], v[156:159], a[210:213], v[76:79]
    ds_read_b64_tr_b16 v[194:195], v206 offset:2304
    v_cvt_pk_bf16_f32 v110, v44, v45
    v_mfma_f32_16x16x16_bf16 v[48:51], v[160:161], a[160:161], v[48:51]
    v_exp_f32_e64 v46, v46
    v_mfma_f32_16x16x16_bf16 v[56:59], v[160:161], a[178:179], v[56:59]
    ds_read_b64_tr_b16 v[196:197], v204 offset:8192
    v_mfma_f32_16x16x16_bf16 v[64:67], v[160:161], a[196:197], v[64:67]
    v_exp_f32_e64 v47, v47
    v_mfma_f32_16x16x16_bf16 v[72:75], v[160:161], a[214:215], v[72:75]
    ds_read_b64_tr_b16 v[198:199], v204 offset:8704
    v_cvt_pk_bf16_f32 v111, v46, v47
    v_mfma_f32_16x16x16_bf16 v[52:55], v[162:163], a[160:161], v[52:55]
    v_mfma_f32_16x16x16_bf16 v[60:63], v[162:163], a[178:179], v[60:63]
    v_mfma_f32_16x16x16_bf16 v[68:71], v[162:163], a[196:197], v[68:71]
    v_mfma_f32_16x16x16_bf16 v[76:79], v[162:163], a[214:215], v[76:79]
    s_waitcnt vmcnt(9) lgkmcnt(0)
    s_nop 0
    v_mfma_f32_16x16x32_bf16 a[0:3], v[164:167], v[96:99], a[0:3]
    v_mfma_f32_16x16x32_bf16 a[36:39], v[164:167], v[100:103], a[36:39]
    s_add_u32 m0, s47, 73728
    ds_read_b128 v[128:131], v1 offset:0
    v_mfma_f32_16x16x32_bf16 a[4:7], v[168:171], v[96:99], a[4:7]
    buffer_load_dwordx4 v6, s[16:19], s44 offen offset:0  lds
    v_mfma_f32_16x16x32_bf16 a[40:43], v[168:171], v[100:103], a[40:43]
    v_exp_f32_e64 v48, v48
    v_mfma_f32_16x16x32_bf16 a[8:11], v[172:175], v[96:99], a[8:11]
    ds_read_b128 v[132:135], v1 offset:256
    v_mfma_f32_16x16x32_bf16 a[44:47], v[172:175], v[100:103], a[44:47]
    v_exp_f32_e64 v49, v49
    v_mfma_f32_16x16x32_bf16 a[12:15], v[176:179], v[96:99], a[12:15]
    buffer_load_dwordx4 v6, s[16:19], s44 offen offset:1024  lds
    v_mfma_f32_16x16x32_bf16 a[48:51], v[176:179], v[100:103], a[48:51]
    ds_read_b128 v[136:139], v1 offset:2048
    v_cvt_pk_bf16_f32 v112, v48, v49
    v_mfma_f32_16x16x32_bf16 a[16:19], v[180:183], v[96:99], a[16:19]
    v_exp_f32_e64 v50, v50
    v_mfma_f32_16x16x32_bf16 a[52:55], v[180:183], v[100:103], a[52:55]
    buffer_load_dwordx4 v6, s[16:19], s44 offen offset:2048  lds
    v_mfma_f32_16x16x32_bf16 a[20:23], v[184:187], v[96:99], a[20:23]
    ds_read_b128 v[140:143], v1 offset:2304
    v_mfma_f32_16x16x32_bf16 a[56:59], v[184:187], v[100:103], a[56:59]
    v_exp_f32_e64 v51, v51
    v_mfma_f32_16x16x32_bf16 a[24:27], v[188:191], v[96:99], a[24:27]
    buffer_load_dwordx4 v6, s[16:19], s44 offen offset:3072  lds
    v_mfma_f32_16x16x32_bf16 a[60:63], v[188:191], v[100:103], a[60:63]
    ds_read_b128 v[144:147], v1 offset:4096
    v_cvt_pk_bf16_f32 v113, v50, v51
    v_mfma_f32_16x16x32_bf16 a[28:31], v[192:195], v[96:99], a[28:31]
    s_add_u32 m0, s47, 77824
    v_exp_f32_e64 v52, v52
    v_mfma_f32_16x16x32_bf16 a[64:67], v[192:195], v[100:103], a[64:67]
    buffer_load_dwordx4 v7, s[16:19], s44 offen offset:0  lds
    v_mfma_f32_16x16x32_bf16 a[32:35], v[196:199], v[96:99], a[32:35]
    ds_read_b128 v[148:151], v1 offset:4352
    v_mfma_f32_16x16x32_bf16 a[68:71], v[196:199], v[100:103], a[68:71]
    v_exp_f32_e64 v53, v53
    v_mfma_f32_16x16x32_bf16 a[104:107], v[196:199], v[104:107], a[104:107]
    buffer_load_dwordx4 v7, s[16:19], s44 offen offset:1024  lds
    v_mfma_f32_16x16x32_bf16 a[140:143], v[196:199], v[108:111], a[140:143]
    ds_read_b128 v[152:155], v1 offset:6144
    v_cvt_pk_bf16_f32 v114, v52, v53
    v_mfma_f32_16x16x32_bf16 a[100:103], v[192:195], v[104:107], a[100:103]
    v_exp_f32_e64 v54, v54
    v_mfma_f32_16x16x32_bf16 a[136:139], v[192:195], v[108:111], a[136:139]
    buffer_load_dwordx4 v7, s[16:19], s44 offen offset:2048  lds
    v_mfma_f32_16x16x32_bf16 a[96:99], v[188:191], v[104:107], a[96:99]
    ds_read_b128 v[156:159], v1 offset:6400
    v_mfma_f32_16x16x32_bf16 a[132:135], v[188:191], v[108:111], a[132:135]
    v_exp_f32_e64 v55, v55
    v_mfma_f32_16x16x32_bf16 a[92:95], v[184:187], v[104:107], a[92:95]
    buffer_load_dwordx4 v7, s[16:19], s44 offen offset:3072  lds
    v_mfma_f32_16x16x32_bf16 a[128:131], v[184:187], v[108:111], a[128:131]
    ds_read_b64 v[160:161], v2 offset:8192
    v_cvt_pk_bf16_f32 v115, v54, v55
    v_mfma_f32_16x16x32_bf16 a[88:91], v[180:183], v[104:107], a[88:91]
    s_add_u32 m0, s47, 81920
    v_exp_f32_e64 v56, v56
    v_mfma_f32_16x16x32_bf16 a[124:127], v[180:183], v[108:111], a[124:127]
    buffer_load_dwordx4 v8, s[16:19], s44 offen offset:0  lds
    v_mfma_f32_16x16x32_bf16 a[84:87], v[176:179], v[104:107], a[84:87]
    s_add_u32 s44, s44, 36864
    ds_read_b64 v[162:163], v2 offset:8704
    v_mfma_f32_16x16x32_bf16 a[120:123], v[176:179], v[108:111], a[120:123]
    buffer_store_dwordx4 v[216:219], v6, s[12:15], s25 offen offset:2048 sc1
    v_mfma_f32_16x16x32_bf16 a[80:83], v[172:175], v[104:107], a[80:83]
    buffer_load_dword v252, v248, s[12:15], 0 offen sc1
    v_exp_f32_e64 v57, v57
    v_mfma_f32_16x16x32_bf16 a[116:119], v[172:175], v[108:111], a[116:119]
    v_exp_f32_e64 v58, v58
    v_mfma_f32_16x16x32_bf16 a[76:79], v[168:171], v[104:107], a[76:79]
    buffer_store_dwordx2 v[226:227], v246, s[12:15], s27 offen sc1
    v_mfma_f32_16x16x32_bf16 a[112:115], v[168:171], v[108:111], a[112:115]
    v_exp_f32_e64 v59, v59
    v_mfma_f32_16x16x32_bf16 a[72:75], v[164:167], v[104:107], a[72:75]
    v_exp_f32_e64 v60, v60
    v_mfma_f32_16x16x32_bf16 a[108:111], v[164:167], v[108:111], a[108:111]
    s_waitcnt lgkmcnt(0)
    v_exp_f32 v61, v61
    v_mfma_f32_16x16x32_bf16 v[16:19], v[128:131], a[144:147], 0
    v_exp_f32_e64 v62, v62
    v_mfma_f32_16x16x32_bf16 v[16:19], v[136:139], a[148:151], v[16:19]
    ds_read_b64_tr_b16 v[164:165], v202 offset:36864
    v_cvt_pk_bf16_f32 v116, v56, v57
    v_mfma_f32_16x16x32_bf16 v[16:19], v[144:147], a[152:155], v[16:19]
    v_exp_f32_e64 v63, v63
    v_mfma_f32_16x16x32_bf16 v[16:19], v[152:155], a[156:159], v[16:19]
    ds_read_b64_tr_b16 v[166:167], v202 offset:37120
    v_cvt_pk_bf16_f32 v117, v58, v59
    v_mfma_f32_16x16x32_bf16 v[24:27], v[128:131], a[162:165], 0
    v_exp_f32_e64 v64, v64
    v_mfma_f32_16x16x32_bf16 v[24:27], v[136:139], a[166:169], v[24:27]
    ds_read_b64_tr_b16 v[168:169], v203 offset:36864
    v_cvt_pk_bf16_f32 v118, v60, v61
    v_mfma_f32_16x16x32_bf16 v[24:27], v[144:147], a[170:173], v[24:27]
    v_exp_f32_e64 v65, v65
    v_mfma_f32_16x16x32_bf16 v[24:27], v[152:155], a[174:177], v[24:27]
    ds_read_b64_tr_b16 v[170:171], v203 offset:37120
    v_cvt_pk_bf16_f32 v119, v62, v63
    v_mfma_f32_16x16x32_bf16 v[32:35], v[128:131], a[180:183], 0
    v_exp_f32_e64 v66, v66
    v_mfma_f32_16x16x32_bf16 v[32:35], v[136:139], a[184:187], v[32:35]
    ds_read_b64_tr_b16 v[172:173], v202 offset:38912
    v_cvt_pk_bf16_f32 v120, v64, v65
    v_mfma_f32_16x16x32_bf16 v[32:35], v[144:147], a[188:191], v[32:35]
    v_exp_f32_e64 v67, v67
    v_mfma_f32_16x16x32_bf16 v[32:35], v[152:155], a[192:195], v[32:35]
    ds_read_b64_tr_b16 v[174:175], v202 offset:39168
    v_cvt_pk_bf16_f32 v121, v66, v67
    v_mfma_f32_16x16x32_bf16 v[40:43], v[128:131], a[198:201], 0
    v_exp_f32_e64 v68, v68
    v_mfma_f32_16x16x32_bf16 v[40:43], v[136:139], a[202:205], v[40:43]
    ds_read_b64_tr_b16 v[176:177], v203 offset:38912
    v_mfma_f32_16x16x32_bf16 v[40:43], v[144:147], a[206:209], v[40:43]
    v_exp_f32_e64 v69, v69
    v_mfma_f32_16x16x32_bf16 v[40:43], v[152:155], a[210:213], v[40:43]
    ds_read_b64_tr_b16 v[178:179], v203 offset:39168
    v_cvt_pk_bf16_f32 v122, v68, v69
    v_mfma_f32_16x16x32_bf16 v[20:23], v[132:135], a[144:147], 0
    v_exp_f32_e64 v70, v70
    v_mfma_f32_16x16x32_bf16 v[20:23], v[140:143], a[148:151], v[20:23]
    ds_read_b64_tr_b16 v[180:181], v205 offset:36864
    v_mfma_f32_16x16x32_bf16 v[20:23], v[148:151], a[152:155], v[20:23]
    v_exp_f32_e64 v71, v71
    v_mfma_f32_16x16x32_bf16 v[20:23], v[156:159], a[156:159], v[20:23]
    ds_read_b64_tr_b16 v[182:183], v205 offset:37120
    v_cvt_pk_bf16_f32 v123, v70, v71
    v_mfma_f32_16x16x32_bf16 v[28:31], v[132:135], a[162:165], 0
    v_exp_f32_e64 v72, v72
    v_mfma_f32_16x16x32_bf16 v[28:31], v[140:143], a[166:169], v[28:31]
    ds_read_b64_tr_b16 v[184:185], v206 offset:36864
    v_mfma_f32_16x16x32_bf16 v[28:31], v[148:151], a[170:173], v[28:31]
    v_exp_f32_e64 v73, v73
    v_mfma_f32_16x16x32_bf16 v[28:31], v[156:159], a[174:177], v[28:31]
    ds_read_b64_tr_b16 v[186:187], v206 offset:37120
    v_cvt_pk_bf16_f32 v124, v72, v73
    v_mfma_f32_16x16x32_bf16 v[36:39], v[132:135], a[180:183], 0
    v_exp_f32_e64 v74, v74
    v_mfma_f32_16x16x32_bf16 v[36:39], v[140:143], a[184:187], v[36:39]
    ds_read_b64_tr_b16 v[188:189], v205 offset:38912
    v_mfma_f32_16x16x32_bf16 v[36:39], v[148:151], a[188:191], v[36:39]
    v_exp_f32_e64 v75, v75
    v_mfma_f32_16x16x32_bf16 v[36:39], v[156:159], a[192:195], v[36:39]
    ds_read_b64_tr_b16 v[190:191], v205 offset:39168
    v_cvt_pk_bf16_f32 v125, v74, v75
    v_mfma_f32_16x16x32_bf16 v[44:47], v[132:135], a[198:201], 0
    v_exp_f32_e64 v76, v76
    v_mfma_f32_16x16x32_bf16 v[44:47], v[140:143], a[202:205], v[44:47]
    ds_read_b64_tr_b16 v[192:193], v206 offset:38912
    v_mfma_f32_16x16x32_bf16 v[44:47], v[148:151], a[206:209], v[44:47]
    v_exp_f32_e64 v77, v77
    v_mfma_f32_16x16x32_bf16 v[44:47], v[156:159], a[210:213], v[44:47]
    ds_read_b64_tr_b16 v[194:195], v206 offset:39168
    v_cvt_pk_bf16_f32 v126, v76, v77
    v_mfma_f32_16x16x16_bf16 v[16:19], v[160:161], a[160:161], v[16:19]
    v_exp_f32_e64 v78, v78
    v_mfma_f32_16x16x16_bf16 v[24:27], v[160:161], a[178:179], v[24:27]
    ds_read_b64_tr_b16 v[196:197], v204 offset:45056
    v_mfma_f32_16x16x16_bf16 v[32:35], v[160:161], a[196:197], v[32:35]
    v_exp_f32_e64 v79, v79
    v_mfma_f32_16x16x16_bf16 v[40:43], v[160:161], a[214:215], v[40:43]
    ds_read_b64_tr_b16 v[198:199], v204 offset:45568
    v_cvt_pk_bf16_f32 v127, v78, v79
    v_mfma_f32_16x16x16_bf16 v[20:23], v[162:163], a[160:161], v[20:23]
    v_mfma_f32_16x16x16_bf16 v[28:31], v[162:163], a[178:179], v[28:31]
    v_mfma_f32_16x16x16_bf16 v[36:39], v[162:163], a[196:197], v[36:39]
    v_mfma_f32_16x16x16_bf16 v[44:47], v[162:163], a[214:215], v[44:47]
    s_waitcnt vmcnt(9) lgkmcnt(0)
    s_nop 0
    v_mfma_f32_16x16x32_bf16 a[0:3], v[164:167], v[112:115], a[0:3]
    v_mfma_f32_16x16x32_bf16 a[36:39], v[164:167], v[116:119], a[36:39]
    s_add_u32 m0, s47, 110592
    ds_read_b128 v[128:131], v1 offset:36864
    v_mfma_f32_16x16x32_bf16 a[4:7], v[168:171], v[112:115], a[4:7]
L_t2:
    s_cbranch_execz L_tr
    buffer_load_dwordx4 v6, s[16:19], s44 offen offset:0  lds
    v_mfma_f32_16x16x32_bf16 a[40:43], v[168:171], v[116:119], a[40:43]
    s_and_b32 s52, s45, 1
    v_exp_f32_e64 v16, v16
    v_mfma_f32_16x16x32_bf16 a[8:11], v[172:175], v[112:115], a[8:11]
    v_mov_b32_e64 v249, s52
    ds_read_b128 v[132:135], v1 offset:37120
    v_mfma_f32_16x16x32_bf16 a[44:47], v[172:175], v[116:119], a[44:47]
    v_exp_f32_e64 v17, v17
    v_mfma_f32_16x16x32_bf16 a[12:15], v[176:179], v[112:115], a[12:15]
    buffer_load_dwordx4 v6, s[16:19], s44 offen offset:1024  lds
    v_mfma_f32_16x16x32_bf16 a[48:51], v[176:179], v[116:119], a[48:51]
    ds_read_b128 v[136:139], v1 offset:38912
    v_cvt_pk_bf16_f32 v96, v16, v17
    v_mfma_f32_16x16x32_bf16 a[16:19], v[180:183], v[112:115], a[16:19]
    ds_add_rtn_u32 v230, v231, v249
    v_exp_f32_e64 v18, v18
    v_mfma_f32_16x16x32_bf16 a[52:55], v[180:183], v[116:119], a[52:55]
    buffer_load_dwordx4 v6, s[16:19], s44 offen offset:2048  lds
    v_mfma_f32_16x16x32_bf16 a[20:23], v[184:187], v[112:115], a[20:23]
    ds_read_b128 v[140:143], v1 offset:39168
    v_mfma_f32_16x16x32_bf16 a[56:59], v[184:187], v[116:119], a[56:59]
    v_exp_f32_e64 v19, v19
    v_mfma_f32_16x16x32_bf16 a[24:27], v[188:191], v[112:115], a[24:27]
    buffer_load_dwordx4 v6, s[16:19], s44 offen offset:3072  lds
    v_mfma_f32_16x16x32_bf16 a[60:63], v[188:191], v[116:119], a[60:63]
    ds_read_b128 v[144:147], v1 offset:40960
    v_cvt_pk_bf16_f32 v97, v18, v19
    v_mfma_f32_16x16x32_bf16 a[28:31], v[192:195], v[112:115], a[28:31]
    s_add_u32 m0, s47, 114688
    v_exp_f32_e64 v20, v20
    v_mfma_f32_16x16x32_bf16 a[64:67], v[192:195], v[116:119], a[64:67]
    buffer_load_dwordx4 v7, s[16:19], s44 offen offset:0  lds
    v_mfma_f32_16x16x32_bf16 a[32:35], v[196:199], v[112:115], a[32:35]
    ds_read_b128 v[148:151], v1 offset:41216
    v_mfma_f32_16x16x32_bf16 a[68:71], v[196:199], v[116:119], a[68:71]
    v_exp_f32_e64 v21, v21
    v_mfma_f32_16x16x32_bf16 a[104:107], v[196:199], v[120:123], a[104:107]
    buffer_load_dwordx4 v7, s[16:19], s44 offen offset:1024  lds
    v_mfma_f32_16x16x32_bf16 a[140:143], v[196:199], v[124:127], a[140:143]
    ds_read_b128 v[152:155], v1 offset:43008
    v_cvt_pk_bf16_f32 v98, v20, v21
    v_mfma_f32_16x16x32_bf16 a[100:103], v[192:195], v[120:123], a[100:103]
    v_exp_f32_e64 v22, v22
    v_mfma_f32_16x16x32_bf16 a[136:139], v[192:195], v[124:127], a[136:139]
    buffer_load_dwordx4 v7, s[16:19], s44 offen offset:2048  lds
    v_mfma_f32_16x16x32_bf16 a[96:99], v[188:191], v[120:123], a[96:99]
    ds_read_b128 v[156:159], v1 offset:43264
    v_mfma_f32_16x16x32_bf16 a[132:135], v[188:191], v[124:127], a[132:135]
    v_exp_f32_e64 v23, v23
    v_mfma_f32_16x16x32_bf16 a[92:95], v[184:187], v[120:123], a[92:95]
    buffer_load_dwordx4 v7, s[16:19], s44 offen offset:3072  lds
    v_mfma_f32_16x16x32_bf16 a[128:131], v[184:187], v[124:127], a[128:131]
    ds_read_b64 v[160:161], v2 offset:45056
    v_cvt_pk_bf16_f32 v99, v22, v23
    v_mfma_f32_16x16x32_bf16 a[88:91], v[180:183], v[120:123], a[88:91]
    s_add_u32 m0, s47, 118784
    v_exp_f32_e64 v24, v24
    v_mfma_f32_16x16x32_bf16 a[124:127], v[180:183], v[124:127], a[124:127]
    buffer_load_dwordx4 v8, s[16:19], s44 offen offset:0  lds
    v_mfma_f32_16x16x32_bf16 a[84:87], v[176:179], v[120:123], a[84:87]
    s_add_u32 s44, s44, 36864
    ds_read_b64 v[162:163], v2 offset:45568
    v_mfma_f32_16x16x32_bf16 a[120:123], v[176:179], v[124:127], a[120:123]
    buffer_store_dwordx4 v[220:223], v6, s[12:15], s25 offen offset:3072 sc1
    v_mfma_f32_16x16x32_bf16 a[80:83], v[172:175], v[120:123], a[80:83]
    s_mov_b32 s26, 2.0
    v_exp_f32 v25, v25
    v_mfma_f32_16x16x32_bf16 a[116:119], v[172:175], v[124:127], a[116:119]
    s_mov_b32 s27, 2.0
    v_exp_f32 v26, v26
    v_mfma_f32_16x16x32_bf16 a[76:79], v[168:171], v[120:123], a[76:79]
    v_mfma_f32_16x16x32_bf16 a[112:115], v[168:171], v[124:127], a[112:115]
    s_cmp_eq_u32 s45, 2
    v_exp_f32 v27, v27
    v_mfma_f32_16x16x32_bf16 a[72:75], v[164:167], v[120:123], a[72:75]
    v_exp_f32_e64 v28, v28
    v_mfma_f32_16x16x32_bf16 a[108:111], v[164:167], v[124:127], a[108:111]
    s_waitcnt lgkmcnt(0)
    v_exp_f32_e64 v29, v29
    s_cbranch_scc1 L_last
L_lastb:
    v_mfma_f32_16x16x32_bf16 v[48:51], v[128:131], a[144:147], 0
    v_exp_f32_e64 v30, v30
    v_mfma_f32_16x16x32_bf16 v[48:51], v[136:139], a[148:151], v[48:51]
    v_readfirstlane_b32 s52, v230
    ds_read_b64_tr_b16 v[164:165], v3 offset:0
    v_cvt_pk_bf16_f32 v100, v24, v25
    v_mfma_f32_16x16x32_bf16 v[48:51], v[144:147], a[152:155], v[48:51]
    s_lshl2_add_u32 s52, s45, s52
    v_exp_f32_e64 v31, v31
    v_mfma_f32_16x16x32_bf16 v[48:51], v[152:155], a[156:159], v[48:51]
    s_cmp_eq_u32 s52, 7
    ds_read_b64_tr_b16 v[166:167], v3 offset:256
    v_cvt_pk_bf16_f32 v101, v26, v27
    v_mfma_f32_16x16x32_bf16 v[56:59], v[128:131], a[162:165], 0
    s_cselect_b32 s52, s99, 2.0
    v_exp_f32_e64 v32, v32
    v_mfma_f32_16x16x32_bf16 v[56:59], v[136:139], a[166:169], v[56:59]
    ds_read_b64_tr_b16 v[168:169], v4 offset:0
    v_cvt_pk_bf16_f32 v102, v28, v29
    v_mfma_f32_16x16x32_bf16 v[56:59], v[144:147], a[170:173], v[56:59]
    buffer_store_dword v207, v231, s[12:15], s52 offen sc1
    v_exp_f32_e64 v33, v33
    v_mfma_f32_16x16x32_bf16 v[56:59], v[152:155], a[174:177], v[56:59]
    ds_read_b64_tr_b16 v[170:171], v4 offset:256
    v_cvt_pk_bf16_f32 v103, v30, v31
    v_mfma_f32_16x16x32_bf16 v[64:67], v[128:131], a[180:183], 0
    v_exp_f32_e64 v34, v34
    v_mfma_f32_16x16x32_bf16 v[64:67], v[136:139], a[184:187], v[64:67]
    ds_read_b64_tr_b16 v[172:173], v3 offset:2048
    v_cvt_pk_bf16_f32 v104, v32, v33
    v_mfma_f32_16x16x32_bf16 v[64:67], v[144:147], a[188:191], v[64:67]
    v_exp_f32_e64 v35, v35
    v_mfma_f32_16x16x32_bf16 v[64:67], v[152:155], a[192:195], v[64:67]
    ds_read_b64_tr_b16 v[174:175], v3 offset:2304
    v_cvt_pk_bf16_f32 v105, v34, v35
    v_mfma_f32_16x16x32_bf16 v[72:75], v[128:131], a[198:201], 0
    v_exp_f32_e64 v36, v36
    v_mfma_f32_16x16x32_bf16 v[72:75], v[136:139], a[202:205], v[72:75]
    ds_read_b64_tr_b16 v[176:177], v4 offset:2048
    v_mfma_f32_16x16x32_bf16 v[72:75], v[144:147], a[206:209], v[72:75]
    v_exp_f32_e64 v37, v37
    v_mfma_f32_16x16x32_bf16 v[72:75], v[152:155], a[210:213], v[72:75]
    ds_read_b64_tr_b16 v[178:179], v4 offset:2304
    v_cvt_pk_bf16_f32 v106, v36, v37
    v_mfma_f32_16x16x32_bf16 v[52:55], v[132:135], a[144:147], 0
    v_exp_f32_e64 v38, v38
    v_mfma_f32_16x16x32_bf16 v[52:55], v[140:143], a[148:151], v[52:55]
    ds_read_b64_tr_b16 v[180:181], v14 offset:0
    v_mfma_f32_16x16x32_bf16 v[52:55], v[148:151], a[152:155], v[52:55]
    v_exp_f32_e64 v39, v39
    v_mfma_f32_16x16x32_bf16 v[52:55], v[156:159], a[156:159], v[52:55]
    ds_read_b64_tr_b16 v[182:183], v14 offset:256
    v_cvt_pk_bf16_f32 v107, v38, v39
    v_mfma_f32_16x16x32_bf16 v[60:63], v[132:135], a[162:165], 0
    v_exp_f32_e64 v40, v40
    v_mfma_f32_16x16x32_bf16 v[60:63], v[140:143], a[166:169], v[60:63]
    ds_read_b64_tr_b16 v[184:185], v15 offset:0
    v_mfma_f32_16x16x32_bf16 v[60:63], v[148:151], a[170:173], v[60:63]
    v_exp_f32_e64 v41, v41
    v_mfma_f32_16x16x32_bf16 v[60:63], v[156:159], a[174:177], v[60:63]
    ds_read_b64_tr_b16 v[186:187], v15 offset:256
    v_cvt_pk_bf16_f32 v108, v40, v41
    v_mfma_f32_16x16x32_bf16 v[68:71], v[132:135], a[180:183], 0
    v_exp_f32_e64 v42, v42
    v_mfma_f32_16x16x32_bf16 v[68:71], v[140:143], a[184:187], v[68:71]
    ds_read_b64_tr_b16 v[188:189], v14 offset:2048
    v_mfma_f32_16x16x32_bf16 v[68:71], v[148:151], a[188:191], v[68:71]
    v_exp_f32_e64 v43, v43
    v_mfma_f32_16x16x32_bf16 v[68:71], v[156:159], a[192:195], v[68:71]
    ds_read_b64_tr_b16 v[190:191], v14 offset:2304
    v_cvt_pk_bf16_f32 v109, v42, v43
    v_mfma_f32_16x16x32_bf16 v[76:79], v[132:135], a[198:201], 0
    v_exp_f32_e64 v44, v44
    v_mfma_f32_16x16x32_bf16 v[76:79], v[140:143], a[202:205], v[76:79]
    ds_read_b64_tr_b16 v[192:193], v15 offset:2048
    v_mfma_f32_16x16x32_bf16 v[76:79], v[148:151], a[206:209], v[76:79]
    v_exp_f32_e64 v45, v45
    v_mfma_f32_16x16x32_bf16 v[76:79], v[156:159], a[210:213], v[76:79]
    ds_read_b64_tr_b16 v[194:195], v15 offset:2304
    v_cvt_pk_bf16_f32 v110, v44, v45
    v_mfma_f32_16x16x16_bf16 v[48:51], v[160:161], a[160:161], v[48:51]
    v_exp_f32_e64 v46, v46
    v_mfma_f32_16x16x16_bf16 v[56:59], v[160:161], a[178:179], v[56:59]
    ds_read_b64_tr_b16 v[196:197], v5 offset:8192
    v_mfma_f32_16x16x16_bf16 v[64:67], v[160:161], a[196:197], v[64:67]
    v_exp_f32_e64 v47, v47
    v_mfma_f32_16x16x16_bf16 v[72:75], v[160:161], a[214:215], v[72:75]
    ds_read_b64_tr_b16 v[198:199], v5 offset:8704
    v_cvt_pk_bf16_f32 v111, v46, v47
    v_mfma_f32_16x16x16_bf16 v[52:55], v[162:163], a[160:161], v[52:55]
    v_mfma_f32_16x16x16_bf16 v[60:63], v[162:163], a[178:179], v[60:63]
    v_mfma_f32_16x16x16_bf16 v[68:71], v[162:163], a[196:197], v[68:71]
    v_mfma_f32_16x16x16_bf16 v[76:79], v[162:163], a[214:215], v[76:79]
    s_waitcnt vmcnt(9) lgkmcnt(0)
    v_mfma_f32_16x16x32_bf16 a[0:3], v[164:167], v[96:99], a[0:3]
    v_mfma_f32_16x16x32_bf16 a[36:39], v[164:167], v[100:103], a[36:39]
    s_add_u32 m0, s47, 0
    ds_read_b128 v[128:131], v200 offset:0
    v_mfma_f32_16x16x32_bf16 a[4:7], v[168:171], v[96:99], a[4:7]
    buffer_load_dwordx4 v6, s[16:19], s44 offen offset:0  lds
    v_mfma_f32_16x16x32_bf16 a[40:43], v[168:171], v[100:103], a[40:43]
    v_exp_f32_e64 v48, v48
    v_mfma_f32_16x16x32_bf16 a[8:11], v[172:175], v[96:99], a[8:11]
    ds_read_b128 v[132:135], v200 offset:256
    v_mfma_f32_16x16x32_bf16 a[44:47], v[172:175], v[100:103], a[44:47]
    v_exp_f32_e64 v49, v49
    v_mfma_f32_16x16x32_bf16 a[12:15], v[176:179], v[96:99], a[12:15]
    buffer_load_dwordx4 v6, s[16:19], s44 offen offset:1024  lds
    v_mfma_f32_16x16x32_bf16 a[48:51], v[176:179], v[100:103], a[48:51]
    ds_read_b128 v[136:139], v200 offset:2048
    v_cvt_pk_bf16_f32 v112, v48, v49
    v_mfma_f32_16x16x32_bf16 a[16:19], v[180:183], v[96:99], a[16:19]
    v_exp_f32_e64 v50, v50
    v_mfma_f32_16x16x32_bf16 a[52:55], v[180:183], v[100:103], a[52:55]
    buffer_load_dwordx4 v6, s[16:19], s44 offen offset:2048  lds
    v_mfma_f32_16x16x32_bf16 a[20:23], v[184:187], v[96:99], a[20:23]
    ds_read_b128 v[140:143], v200 offset:2304
    v_mfma_f32_16x16x32_bf16 a[56:59], v[184:187], v[100:103], a[56:59]
    v_exp_f32_e64 v51, v51
    v_mfma_f32_16x16x32_bf16 a[24:27], v[188:191], v[96:99], a[24:27]
    buffer_load_dwordx4 v6, s[16:19], s44 offen offset:3072  lds
    v_mfma_f32_16x16x32_bf16 a[60:63], v[188:191], v[100:103], a[60:63]
    ds_read_b128 v[144:147], v200 offset:4096
    v_cvt_pk_bf16_f32 v113, v50, v51
    v_mfma_f32_16x16x32_bf16 a[28:31], v[192:195], v[96:99], a[28:31]
    s_add_u32 m0, s47, 4096
    v_exp_f32_e64 v52, v52
    v_mfma_f32_16x16x32_bf16 a[64:67], v[192:195], v[100:103], a[64:67]
    buffer_load_dwordx4 v7, s[16:19], s44 offen offset:0  lds
    v_mfma_f32_16x16x32_bf16 a[32:35], v[196:199], v[96:99], a[32:35]
    ds_read_b128 v[148:151], v200 offset:4352
    v_mfma_f32_16x16x32_bf16 a[68:71], v[196:199], v[100:103], a[68:71]
    v_exp_f32_e64 v53, v53
    v_mfma_f32_16x16x32_bf16 a[104:107], v[196:199], v[104:107], a[104:107]
    buffer_load_dwordx4 v7, s[16:19], s44 offen offset:1024  lds
    v_mfma_f32_16x16x32_bf16 a[140:143], v[196:199], v[108:111], a[140:143]
    ds_read_b128 v[152:155], v200 offset:6144
    v_cvt_pk_bf16_f32 v114, v52, v53
    v_mfma_f32_16x16x32_bf16 a[100:103], v[192:195], v[104:107], a[100:103]
    v_exp_f32_e64 v54, v54
    v_mfma_f32_16x16x32_bf16 a[136:139], v[192:195], v[108:111], a[136:139]
    buffer_load_dwordx4 v7, s[16:19], s44 offen offset:2048  lds
    v_mfma_f32_16x16x32_bf16 a[96:99], v[188:191], v[104:107], a[96:99]
    ds_read_b128 v[156:159], v200 offset:6400
    v_mfma_f32_16x16x32_bf16 a[132:135], v[188:191], v[108:111], a[132:135]
    v_exp_f32_e64 v55, v55
    v_mfma_f32_16x16x32_bf16 a[92:95], v[184:187], v[104:107], a[92:95]
    buffer_load_dwordx4 v7, s[16:19], s44 offen offset:3072  lds
    v_mfma_f32_16x16x32_bf16 a[128:131], v[184:187], v[108:111], a[128:131]
    ds_read_b64 v[160:161], v201 offset:8192
    v_cvt_pk_bf16_f32 v115, v54, v55
    v_mfma_f32_16x16x32_bf16 a[88:91], v[180:183], v[104:107], a[88:91]
    s_add_u32 m0, s47, 8192
    v_exp_f32_e64 v56, v56
    v_mfma_f32_16x16x32_bf16 a[124:127], v[180:183], v[108:111], a[124:127]
    buffer_load_dwordx4 v8, s[16:19], s44 offen offset:0  lds
    v_mfma_f32_16x16x32_bf16 a[84:87], v[176:179], v[104:107], a[84:87]
    s_add_u32 s44, s44, s24
    s_nop 0
    ds_read_b64 v[162:163], v201 offset:8704
    v_mfma_f32_16x16x32_bf16 a[120:123], v[176:179], v[108:111], a[120:123]
    buffer_store_dwordx2 v[224:225], v246, s[12:15], s25 offen sc1
    v_mfma_f32_16x16x32_bf16 a[80:83], v[172:175], v[104:107], a[80:83]
    v_exp_f32_e64 v57, v57
    v_mfma_f32_16x16x32_bf16 a[116:119], v[172:175], v[108:111], a[116:119]
    s_mov_b32 s25, 2.0
    v_exp_f32 v58, v58
    v_mfma_f32_16x16x32_bf16 a[76:79], v[168:171], v[104:107], a[76:79]
    s_add_u32 s45, s45, 1
    v_mfma_f32_16x16x32_bf16 a[112:115], v[168:171], v[108:111], a[112:115]
    v_exp_f32 v59, v59
    v_mfma_f32_16x16x32_bf16 a[72:75], v[164:167], v[104:107], a[72:75]
    v_exp_f32_e64 v60, v60
    v_mfma_f32_16x16x32_bf16 a[108:111], v[164:167], v[108:111], a[108:111]
    s_waitcnt lgkmcnt(0)
    v_exp_f32_e64 v61, v61
    s_branch L_loop
L_p14:
    s_cmp_eq_u32 s46, 4
    s_cbranch_scc1 L_no15
    v_mfma_f32_16x16x32_bf16 v[48:51], v[128:131], a[144:147], 0
    s_waitcnt vmcnt(9)
    v_exp_f32 v30, v30
    v_mfma_f32_16x16x32_bf16 v[48:51], v[136:139], a[148:151], v[48:51]
    ds_read_b64_tr_b16 v[164:165], v202 offset:0
    v_cvt_pk_bf16_f32 v100, v24, v25
    v_mfma_f32_16x16x32_bf16 v[48:51], v[144:147], a[152:155], v[48:51]
    ds_read_b128 a[216:219], v250 offset:0
    v_exp_f32_e64 v31, v31
    v_mfma_f32_16x16x32_bf16 v[48:51], v[152:155], a[156:159], v[48:51]
    ds_read_b64_tr_b16 v[166:167], v202 offset:256
    v_cvt_pk_bf16_f32 v101, v26, v27
    v_mfma_f32_16x16x32_bf16 v[56:59], v[128:131], a[162:165], 0
    buffer_load_dwordx4 v[208:211], v6, s[12:15], s66 offen offset:0
    v_exp_f32_e64 v32, v32
    v_mfma_f32_16x16x32_bf16 v[56:59], v[136:139], a[166:169], v[56:59]
    ds_read_b64_tr_b16 v[168:169], v203 offset:0
    v_cvt_pk_bf16_f32 v102, v28, v29
    v_mfma_f32_16x16x32_bf16 v[56:59], v[144:147], a[170:173], v[56:59]
    ds_read_b128 a[220:223], v250 offset:1024
    v_exp_f32_e64 v33, v33
    v_mfma_f32_16x16x32_bf16 v[56:59], v[152:155], a[174:177], v[56:59]
    ds_read_b64_tr_b16 v[170:171], v203 offset:256
    v_cvt_pk_bf16_f32 v103, v30, v31
    v_mfma_f32_16x16x32_bf16 v[64:67], v[128:131], a[180:183], 0
    ds_read_b128 a[224:227], v250 offset:2048
    v_exp_f32_e64 v34, v34
    v_mfma_f32_16x16x32_bf16 v[64:67], v[136:139], a[184:187], v[64:67]
    ds_read_b64_tr_b16 v[172:173], v202 offset:2048
    v_cvt_pk_bf16_f32 v104, v32, v33
    v_mfma_f32_16x16x32_bf16 v[64:67], v[144:147], a[188:191], v[64:67]
    buffer_load_dwordx4 v[212:215], v6, s[12:15], s66 offen offset:1024
    v_exp_f32_e64 v35, v35
    v_mfma_f32_16x16x32_bf16 v[64:67], v[152:155], a[192:195], v[64:67]
    ds_read_b64_tr_b16 v[174:175], v202 offset:2304
    v_cvt_pk_bf16_f32 v105, v34, v35
    v_mfma_f32_16x16x32_bf16 v[72:75], v[128:131], a[198:201], 0
    ds_read_b128 a[228:231], v250 offset:3072
    v_exp_f32_e64 v36, v36
    v_mfma_f32_16x16x32_bf16 v[72:75], v[136:139], a[202:205], v[72:75]
    ds_read_b64_tr_b16 v[176:177], v203 offset:2048
    v_mfma_f32_16x16x32_bf16 v[72:75], v[144:147], a[206:209], v[72:75]
    ds_read_b64 a[248:249], v251 offset:0
    v_exp_f32_e64 v37, v37
    v_mfma_f32_16x16x32_bf16 v[72:75], v[152:155], a[210:213], v[72:75]
    ds_read_b64_tr_b16 v[178:179], v203 offset:2304
    v_cvt_pk_bf16_f32 v106, v36, v37
    v_mfma_f32_16x16x32_bf16 v[52:55], v[132:135], a[144:147], 0
    buffer_load_dwordx4 v[216:219], v6, s[12:15], s66 offen offset:2048
    v_exp_f32_e64 v38, v38
    v_mfma_f32_16x16x32_bf16 v[52:55], v[140:143], a[148:151], v[52:55]
    ds_read_b64_tr_b16 v[180:181], v205 offset:0
    v_mfma_f32_16x16x32_bf16 v[52:55], v[148:151], a[152:155], v[52:55]
    ds_read_b128 a[232:235], v250 offset:4608
    v_exp_f32_e64 v39, v39
    v_mfma_f32_16x16x32_bf16 v[52:55], v[156:159], a[156:159], v[52:55]
    ds_read_b64_tr_b16 v[182:183], v205 offset:256
    v_cvt_pk_bf16_f32 v107, v38, v39
    v_mfma_f32_16x16x32_bf16 v[60:63], v[132:135], a[162:165], 0
    ds_read_b128 a[236:239], v250 offset:5632
    v_exp_f32_e64 v40, v40
    v_mfma_f32_16x16x32_bf16 v[60:63], v[140:143], a[166:169], v[60:63]
    ds_read_b64_tr_b16 v[184:185], v206 offset:0
    v_mfma_f32_16x16x32_bf16 v[60:63], v[148:151], a[170:173], v[60:63]
    buffer_load_dwordx4 v[220:223], v6, s[12:15], s66 offen offset:3072
    v_exp_f32_e64 v41, v41
    v_mfma_f32_16x16x32_bf16 v[60:63], v[156:159], a[174:177], v[60:63]
    ds_read_b64_tr_b16 v[186:187], v206 offset:256
    v_cvt_pk_bf16_f32 v108, v40, v41
    v_mfma_f32_16x16x32_bf16 v[68:71], v[132:135], a[180:183], 0
    ds_read_b128 a[240:243], v250 offset:6656
    v_exp_f32_e64 v42, v42
    v_mfma_f32_16x16x32_bf16 v[68:71], v[140:143], a[184:187], v[68:71]
    ds_read_b64_tr_b16 v[188:189], v205 offset:2048
    v_mfma_f32_16x16x32_bf16 v[68:71], v[148:151], a[188:191], v[68:71]
    ds_read_b128 a[244:247], v250 offset:7680
    v_exp_f32_e64 v43, v43
    v_mfma_f32_16x16x32_bf16 v[68:71], v[156:159], a[192:195], v[68:71]
    ds_read_b64_tr_b16 v[190:191], v205 offset:2304
    v_cvt_pk_bf16_f32 v109, v42, v43
    v_mfma_f32_16x16x32_bf16 v[76:79], v[132:135], a[198:201], 0
    buffer_load_dwordx2 v[224:225], v246, s[12:15], s66 offen
    v_exp_f32_e64 v44, v44
    v_mfma_f32_16x16x32_bf16 v[76:79], v[140:143], a[202:205], v[76:79]
    ds_read_b64_tr_b16 v[192:193], v206 offset:2048
    v_mfma_f32_16x16x32_bf16 v[76:79], v[148:151], a[206:209], v[76:79]
    ds_read_b64 a[252:253], v251 offset:4608
    v_exp_f32_e64 v45, v45
    v_mfma_f32_16x16x32_bf16 v[76:79], v[156:159], a[210:213], v[76:79]
    ds_read_b64_tr_b16 v[194:195], v206 offset:2304
    v_cvt_pk_bf16_f32 v110, v44, v45
    v_mfma_f32_16x16x16_bf16 v[48:51], v[160:161], a[160:161], v[48:51]
    v_exp_f32_e64 v46, v46
    v_mfma_f32_16x16x16_bf16 v[56:59], v[160:161], a[178:179], v[56:59]
    ds_read_b64_tr_b16 v[196:197], v204 offset:8192
    v_mfma_f32_16x16x16_bf16 v[64:67], v[160:161], a[196:197], v[64:67]
    v_exp_f32_e64 v47, v47
    v_mfma_f32_16x16x16_bf16 v[72:75], v[160:161], a[214:215], v[72:75]
    ds_read_b64_tr_b16 v[198:199], v204 offset:8704
    v_cvt_pk_bf16_f32 v111, v46, v47
    v_mfma_f32_16x16x16_bf16 v[52:55], v[162:163], a[160:161], v[52:55]
    v_mfma_f32_16x16x16_bf16 v[60:63], v[162:163], a[178:179], v[60:63]
    v_mfma_f32_16x16x16_bf16 v[68:71], v[162:163], a[196:197], v[68:71]
    v_mfma_f32_16x16x16_bf16 v[76:79], v[162:163], a[214:215], v[76:79]
    s_waitcnt lgkmcnt(0)
    v_mfma_f32_16x16x32_bf16 a[0:3], v[164:167], v[96:99], a[0:3]
    v_exp_f32 v48, v48
    v_mfma_f32_16x16x32_bf16 a[4:7], v[168:171], v[96:99], a[4:7]
    v_exp_f32_e64 v49, v49
    v_mfma_f32_16x16x32_bf16 a[8:11], v[172:175], v[96:99], a[8:11]
    ds_read_b64_tr_b16 v[128:129], v202 offset:36864
    v_cvt_pk_bf16_f32 v112, v48, v49
    v_mfma_f32_16x16x32_bf16 a[12:15], v[176:179], v[96:99], a[12:15]
    v_exp_f32_e64 v50, v50
    v_mfma_f32_16x16x32_bf16 a[16:19], v[180:183], v[96:99], a[16:19]
    v_exp_f32_e64 v51, v51
    v_mfma_f32_16x16x32_bf16 a[20:23], v[184:187], v[96:99], a[20:23]
    ds_read_b64_tr_b16 v[130:131], v202 offset:37120
    v_cvt_pk_bf16_f32 v113, v50, v51
    v_mfma_f32_16x16x32_bf16 a[24:27], v[188:191], v[96:99], a[24:27]
    v_exp_f32_e64 v52, v52
    v_mfma_f32_16x16x32_bf16 a[28:31], v[192:195], v[96:99], a[28:31]
    v_exp_f32_e64 v53, v53
    v_mfma_f32_16x16x32_bf16 a[32:35], v[196:199], v[96:99], a[32:35]
    ds_read_b64_tr_b16 v[132:133], v203 offset:36864
    v_cvt_pk_bf16_f32 v114, v52, v53
    v_mfma_f32_16x16x32_bf16 a[36:39], v[164:167], v[100:103], a[36:39]
    v_exp_f32_e64 v54, v54
    v_mfma_f32_16x16x32_bf16 a[40:43], v[168:171], v[100:103], a[40:43]
    v_exp_f32_e64 v55, v55
    v_mfma_f32_16x16x32_bf16 a[44:47], v[172:175], v[100:103], a[44:47]
    ds_read_b64_tr_b16 v[134:135], v203 offset:37120
    v_cvt_pk_bf16_f32 v115, v54, v55
    v_mfma_f32_16x16x32_bf16 a[48:51], v[176:179], v[100:103], a[48:51]
    v_exp_f32_e64 v56, v56
    v_mfma_f32_16x16x32_bf16 a[68:71], v[196:199], v[100:103], a[68:71]
    ds_read_b64_tr_b16 v[136:137], v202 offset:38912
    ds_read_b64_tr_b16 v[138:139], v202 offset:39168
    v_mfma_f32_16x16x32_bf16 a[52:55], v[180:183], v[100:103], a[52:55]
    ds_read_b64_tr_b16 v[140:141], v203 offset:38912
    ds_read_b64_tr_b16 v[142:143], v203 offset:39168
    v_mfma_f32_16x16x32_bf16 a[56:59], v[184:187], v[100:103], a[56:59]
    ds_read_b64_tr_b16 v[144:145], v205 offset:36864
    ds_read_b64_tr_b16 v[146:147], v205 offset:37120
    v_mfma_f32_16x16x32_bf16 a[60:63], v[188:191], v[100:103], a[60:63]
    ds_read_b64_tr_b16 v[148:149], v206 offset:36864
    ds_read_b64_tr_b16 v[150:151], v206 offset:37120
    v_mfma_f32_16x16x32_bf16 a[64:67], v[192:195], v[100:103], a[64:67]
    ds_read_b64_tr_b16 v[152:153], v205 offset:38912
    ds_read_b64_tr_b16 v[154:155], v205 offset:39168
    v_exp_f32 v57, v57
    s_waitcnt lgkmcnt(12)
    v_mfma_f32_16x16x32_bf16 a[0:3], v[128:131], v[112:115], a[0:3]
    ds_read_b64_tr_b16 v[156:157], v206 offset:38912
    ds_read_b64_tr_b16 v[158:159], v206 offset:39168
    v_exp_f32 v58, v58
    s_waitcnt lgkmcnt(12)
    v_mfma_f32_16x16x32_bf16 a[4:7], v[132:135], v[112:115], a[4:7]
    ds_read_b64_tr_b16 v[160:161], v204 offset:45056
    ds_read_b64_tr_b16 v[162:163], v204 offset:45568
    v_exp_f32 v59, v59
    s_waitcnt lgkmcnt(12)
    v_mfma_f32_16x16x32_bf16 a[8:11], v[136:139], v[112:115], a[8:11]
    v_exp_f32 v60, v60
    s_waitcnt lgkmcnt(10)
    v_mfma_f32_16x16x32_bf16 a[12:15], v[140:143], v[112:115], a[12:15]
    v_exp_f32 v61, v61
    s_waitcnt lgkmcnt(8)
    v_mfma_f32_16x16x32_bf16 a[16:19], v[144:147], v[112:115], a[16:19]
    v_exp_f32 v62, v62
    s_waitcnt lgkmcnt(6)
    v_mfma_f32_16x16x32_bf16 a[20:23], v[148:151], v[112:115], a[20:23]
    ds_write_b128 v247, a[0:3] offset:0
    v_exp_f32 v63, v63
    s_waitcnt lgkmcnt(5)
    v_mfma_f32_16x16x32_bf16 a[24:27], v[152:155], v[112:115], a[24:27]
    buffer_load_dwordx4 v[24:27], v240, s[12:15], s6 offen offset:0
    v_cvt_pk_bf16_f32 v116, v56, v57
    v_cvt_pk_bf16_f32 v117, v58, v59
    s_waitcnt lgkmcnt(3)
    s_nop 0
    v_mfma_f32_16x16x32_bf16 a[28:31], v[156:159], v[112:115], a[28:31]
    ds_write_b128 v247, a[4:7] offset:1024
    v_cvt_pk_bf16_f32 v118, v60, v61
    v_cvt_pk_bf16_f32 v119, v62, v63
    s_waitcnt lgkmcnt(2)
    v_mfma_f32_16x16x32_bf16 a[32:35], v[160:163], v[112:115], a[32:35]
    buffer_load_dwordx4 v[28:31], v240, s[12:15], s6 offen offset:1024
    v_mfma_f32_16x16x32_bf16 a[36:39], v[128:131], v[116:119], a[36:39]
    v_exp_f32 v64, v64
    v_mfma_f32_16x16x32_bf16 a[40:43], v[132:135], v[116:119], a[40:43]
    ds_write_b128 v247, a[8:11] offset:2048
    v_mfma_f32_16x16x32_bf16 a[44:47], v[136:139], v[116:119], a[44:47]
    buffer_load_dwordx2 v[32:33], v241, s[12:15], s6 offen
    v_mfma_f32_16x16x32_bf16 a[48:51], v[140:143], v[116:119], a[48:51]
    v_exp_f32_e64 v65, v65
    v_mfma_f32_16x16x32_bf16 a[68:71], v[160:163], v[116:119], a[68:71]
    ds_write_b128 v247, a[12:15] offset:3072
    v_mfma_f32_16x16x32_bf16 a[52:55], v[144:147], v[116:119], a[52:55]
    buffer_load_dwordx4 v[16:19], v238, s[12:15], s6 offen offset:0
    v_mfma_f32_16x16x32_bf16 a[56:59], v[148:151], v[116:119], a[56:59]
    ds_write_b128 v247, a[16:19] offset:4096
    v_mfma_f32_16x16x32_bf16 a[60:63], v[152:155], v[116:119], a[60:63]
    buffer_load_dwordx4 v[20:23], v238, s[12:15], s6 offen offset:1024
    v_mfma_f32_16x16x32_bf16 a[64:67], v[156:159], v[116:119], a[64:67]
    v_cvt_pk_bf16_f32 v120, v64, v65
    v_mfma_f32_16x16x32_bf16 a[72:75], v[164:167], v[104:107], a[72:75]
    ds_write_b128 v247, a[20:23] offset:5120
    v_exp_f32_e64 v66, v66
    v_mfma_f32_16x16x32_bf16 a[76:79], v[168:171], v[104:107], a[76:79]
    buffer_load_dwordx2 v[34:35], v239, s[12:15], s6 offen
    v_exp_f32_e64 v67, v67
    v_mfma_f32_16x16x32_bf16 a[80:83], v[172:175], v[104:107], a[80:83]
    v_exp_f32_e64 v68, v68
    v_mfma_f32_16x16x32_bf16 a[84:87], v[176:179], v[104:107], a[84:87]
    ds_write_b128 v247, a[24:27] offset:6144
    v_exp_f32_e64 v69, v69
    v_mfma_f32_16x16x32_bf16 a[88:91], v[180:183], v[104:107], a[88:91]
    buffer_load_dwordx4 v[36:39], v242, s[12:15], s6 offen offset:0
    v_exp_f32_e64 v70, v70
    v_mfma_f32_16x16x32_bf16 a[92:95], v[184:187], v[104:107], a[92:95]
    ds_write_b128 v247, a[28:31] offset:7168
    v_exp_f32_e64 v71, v71
    v_mfma_f32_16x16x32_bf16 a[96:99], v[188:191], v[104:107], a[96:99]
    s_waitcnt vmcnt(7)
    s_nop 0
    ds_read_b128 a[0:3], v250 offset:36864
    buffer_load_dwordx4 v[40:43], v242, s[12:15], s6 offen offset:1024
    v_cvt_pk_bf16_f32 v121, v66, v67
    v_mfma_f32_16x16x32_bf16 a[100:103], v[192:195], v[104:107], a[100:103]
    v_cvt_pk_bf16_f32 v122, v68, v69
    v_cvt_pk_bf16_f32 v123, v70, v71
    v_mfma_f32_16x16x32_bf16 a[104:107], v[196:199], v[104:107], a[104:107]
    ds_write_b128 v247, a[32:35] offset:8192
    s_mov_b64 exec, 0xffff
    ds_write_b32 v245, a32 offset:0
    s_mov_b64 exec, -1
    s_nop 0
    v_mfma_f32_16x16x32_bf16 a[72:75], v[128:131], v[120:123], a[72:75]
    ds_read_b128 a[4:7], v250 offset:37888
    buffer_load_dwordx2 v[44:45], v243, s[12:15], s6 offen
    v_mfma_f32_16x16x32_bf16 a[76:79], v[132:135], v[120:123], a[76:79]
    v_exp_f32_e64 v72, v72
    v_mfma_f32_16x16x32_bf16 a[80:83], v[136:139], v[120:123], a[80:83]
    ds_write_b128 v247, a[36:39] offset:36864
    v_mfma_f32_16x16x32_bf16 a[84:87], v[140:143], v[120:123], a[84:87]
    ds_read_b128 a[8:11], v250 offset:38912
    buffer_load_dwordx4 v[80:83], v238, s[12:15], s5 offen offset:0
    v_mfma_f32_16x16x32_bf16 a[88:91], v[144:147], v[120:123], a[88:91]
    v_exp_f32_e64 v73, v73
    v_mfma_f32_16x16x32_bf16 a[92:95], v[148:151], v[120:123], a[92:95]
    ds_write_b128 v247, a[40:43] offset:37888
    v_mfma_f32_16x16x32_bf16 a[96:99], v[152:155], v[120:123], a[96:99]
    ds_read_b128 a[12:15], v250 offset:39936
    buffer_load_dwordx4 v[84:87], v238, s[12:15], s5 offen offset:1024
    v_mfma_f32_16x16x32_bf16 a[100:103], v[156:159], v[120:123], a[100:103]
    ds_write_b128 v247, a[44:47] offset:38912
    v_mfma_f32_16x16x32_bf16 a[104:107], v[160:163], v[120:123], a[104:107]
    buffer_load_dwordx2 v[88:89], v239, s[12:15], s5 offen
    v_mfma_f32_16x16x32_bf16 a[108:111], v[164:167], v[108:111], a[108:111]
    ds_read_b64 a[250:251], v251 offset:36864
    v_exp_f32_e64 v74, v74
    v_mfma_f32_16x16x32_bf16 a[112:115], v[168:171], v[108:111], a[112:115]
    ds_write_b128 v247, a[48:51] offset:39936
    v_exp_f32_e64 v75, v75
    v_mfma_f32_16x16x32_bf16 a[116:119], v[172:175], v[108:111], a[116:119]
    buffer_load_dwordx4 v[90:93], v244, s[12:15], 0 offen offset:0
    v_exp_f32_e64 v76, v76
    v_mfma_f32_16x16x32_bf16 a[120:123], v[176:179], v[108:111], a[120:123]
    ds_read_b128 a[18:21], v250 offset:41472
    v_exp_f32_e64 v77, v77
    v_mfma_f32_16x16x32_bf16 a[140:143], v[196:199], v[108:111], a[140:143]
    s_not_b64 exec, s[38:39]
    ds_write_b128 v247, a[68:71] offset:45056
    s_mov_b64 exec, -1
    v_exp_f32_e64 v78, v78
    v_mfma_f32_16x16x32_bf16 a[124:127], v[180:183], v[108:111], a[124:127]
    buffer_load_dwordx4 v[252:255], v244, s[12:15], 0 offen offset:256
    v_exp_f32_e64 v79, v79
    v_mfma_f32_16x16x32_bf16 a[128:131], v[184:187], v[108:111], a[128:131]
L_t3:
    s_cbranch_execz L_tr2
    s_nop 0
    ds_write_b128 v250, a[72:75] offset:0
    ds_read_b128 a[22:25], v250 offset:42496
    v_cvt_pk_bf16_f32 v124, v72, v73
    v_cvt_pk_bf16_f32 v125, v74, v75
    v_mfma_f32_16x16x32_bf16 a[132:135], v[188:191], v[108:111], a[132:135]
    buffer_load_dwordx4 v[96:99], v244, s[12:15], 0 offen offset:512
    v_cvt_pk_bf16_f32 v126, v76, v77
    v_cvt_pk_bf16_f32 v127, v78, v79
    v_mfma_f32_16x16x32_bf16 a[136:139], v[192:195], v[108:111], a[136:139]
    ds_read_b128 a[26:29], v250 offset:43520
    v_mfma_f32_16x16x32_bf16 a[108:111], v[128:131], v[124:127], a[108:111]
    ds_write_b128 v250, a[76:79] offset:1024
    v_mfma_f32_16x16x32_bf16 a[112:115], v[132:135], v[124:127], a[112:115]
    buffer_load_dwordx4 v[100:103], v244, s[12:15], 0 offen offset:768
    v_mfma_f32_16x16x32_bf16 a[116:119], v[136:139], v[124:127], a[116:119]
    ds_read_b128 a[30:33], v250 offset:44544
    v_mfma_f32_16x16x32_bf16 a[120:123], v[140:143], v[124:127], a[120:123]
    ds_write_b128 v250, a[80:83] offset:2048
    v_mfma_f32_16x16x32_bf16 a[140:143], v[160:163], v[124:127], a[140:143]
    buffer_load_dwordx4 v[112:115], v244, s[12:15], 0 offen offset:1024
    v_mfma_f32_16x16x32_bf16 a[124:127], v[144:147], v[124:127], a[124:127]
    ds_write_b128 v250, a[84:87] offset:3072
    v_mfma_f32_16x16x32_bf16 a[128:131], v[148:151], v[124:127], a[128:131]
    ds_read_b64 a[254:255], v251 offset:41472
    buffer_load_dwordx4 v[116:119], v244, s[12:15], 0 offen offset:1280
    v_mfma_f32_16x16x32_bf16 a[132:135], v[152:155], v[124:127], a[132:135]
    v_mfma_f32_16x16x32_bf16 a[136:139], v[156:159], v[124:127], a[136:139]
    buffer_load_dwordx4 v[104:107], v244, s[12:15], 0 offen offset:1536
L_e1:
    v_add_u32 v230, s36, v6
    v_add_u32 v231, s37, v6
    v_xor_b32 v10, 256, v245
    s_mov_b64 exec, 0xffff
    ds_write_b32 v245, a104 offset:512
    ds_write_b32 v10, a68 offset:0
    ds_write_b32 v10, a140 offset:512
    s_mov_b64 exec, -1
    v_add_u32 v249, s7, v6
    v_add_u32 v11, 156672, v6
    v_and_b32 v227, 0xf0, v6
    s_lshl_b32 s52, s3, 8
    s_add_u32 s60, s52, 156672
    v_add_u32 v226, s60, v227
    buffer_load_dwordx2 v[94:95], v244, s[12:15], 0 offen offset:1792
    buffer_load_dwordx4 v[192:195], v236, s[8:11], s43 offen
    buffer_load_dwordx4 v[196:199], v237, s[8:11], s43 offen
    buffer_load_dwordx2 v[46:47], v9, s[8:11], 0 offen offset:256
    s_xor_b32 s52, s2, 1
    s_mul_i32 s52, s52, 10240
    s_mul_i32 s61, s3, 5120
    s_add_u32 s61, s61, 6912000
    s_add_u32 s52, s52, s61
    s_lshl_b32 s62, s4, 11
    s_add_u32 s52, s52, 4096
    s_cmp_eq_u32 s4, 0
    s_cselect_b32 s52, 0x40000000, s52
    s_mov_b32 s54, 0x71800000
    s_mov_b32 s55, 0x17800000
    s_mul_i32 s64, s2, 10240
    s_add_u32 s64, s64, s61
    s_waitcnt lgkmcnt(0)
    s_barrier
    ds_read_b128 v[10:13], v11
    ds_read_b128 v[226:229], v226
    ds_read_b128 v[128:131], v230 offset:0
    v_accvgpr_read_b32 v48, a52
    v_accvgpr_read_b32 v49, a53
    ds_read_b128 v[132:135], v230 offset:1024
    v_accvgpr_read_b32 v50, a54
    v_accvgpr_read_b32 v51, a55
    ds_read_b128 v[136:139], v230 offset:2048
    v_accvgpr_read_b32 v52, a56
    v_accvgpr_read_b32 v53, a57
    ds_read_b128 v[140:143], v230 offset:3072
    v_accvgpr_read_b32 v54, a58
    v_accvgpr_read_b32 v55, a59
    ds_read_b128 v[148:151], v231 offset:4096
    v_accvgpr_read_b32 v56, a60
    v_accvgpr_read_b32 v57, a61
    ds_read_b128 v[152:155], v231 offset:5120
    v_accvgpr_read_b32 v58, a62
    v_accvgpr_read_b32 v59, a63
    ds_read_b128 v[156:159], v231 offset:6144
    v_accvgpr_read_b32 v60, a64
    v_accvgpr_read_b32 v61, a65
    ds_read_b128 v[160:163], v231 offset:7168
    v_accvgpr_read_b32 v62, a66
    v_accvgpr_read_b32 v63, a67
    ds_read_b128 v[72:75], v249 offset:0
    v_accvgpr_read_b32 v64, a68
    v_accvgpr_read_b32 v65, a69
    ds_read_b128 v[76:79], v249 offset:1024
    v_accvgpr_read_b32 v66, a70
    v_accvgpr_read_b32 v67, a71
    ds_read_b128 v[200:203], v249 offset:2048
    ds_read_b128 v[204:207], v249 offset:3072
    s_mov_b64 exec, s[38:39]
    ds_read_b128 v[144:147], v230 offset:8192
    ds_read_b128 v[68:71], v231 offset:8192
    ds_read_b128 v[108:111], v249 offset:8192
    s_mov_b64 exec, -1
    s_waitcnt lgkmcnt(11)
    v_add_f32 v10, v10, v11
    v_add_f32 v12, v12, v13
    v_add_f32 v226, v226, v227
    v_add_f32 v10, v10, v12
    v_add_f32_e64 v228, v228, v229
    v_cmp_nge_f32 vcc, s54, v10
    v_cmp_gt_f32 s[56:57], s55, v10
    v_pk_add_f32 v[48:49], v[48:49], v[128:129]
    v_pk_add_f32 v[50:51], v[50:51], v[130:131]
    v_pk_add_f32 v[52:53], v[52:53], v[132:133]
    v_pk_add_f32 v[54:55], v[54:55], v[134:135]
    v_pk_add_f32 v[56:57], v[56:57], v[136:137]
    v_pk_add_f32 v[58:59], v[58:59], v[138:139]
    v_pk_add_f32 v[60:61], v[60:61], v[140:141]
    v_pk_add_f32 v[62:63], v[62:63], v[142:143]
    s_or_b64 vcc, vcc, s[56:57]
    s_cselect_b32 s54, 1, 0
    s_andn2_b32 s54, s54, s51
    s_cbranch_scc1 L_fallback
    v_add_f32 v138, v226, v228
    v_mov_b32_e64 v139, v233
    s_waitcnt lgkmcnt(7)
    v_pk_add_f32 v[48:49], v[48:49], v[148:149]
    v_pk_add_f32 v[50:51], v[50:51], v[150:151]
    v_pk_add_f32 v[52:53], v[52:53], v[152:153]
    v_pk_add_f32 v[54:55], v[54:55], v[154:155]
    v_pk_add_f32 v[56:57], v[56:57], v[156:157]
    v_pk_add_f32 v[58:59], v[58:59], v[158:159]
    v_pk_add_f32 v[60:61], v[60:61], v[160:161]
    v_pk_add_f32 v[62:63], v[62:63], v[162:163]
    s_waitcnt lgkmcnt(3)
    s_nop 0
    v_pk_add_f32 v[48:49], v[48:49], v[72:73]
    v_pk_add_f32 v[50:51], v[50:51], v[74:75]
    v_pk_add_f32 v[52:53], v[52:53], v[76:77]
    v_pk_add_f32 v[54:55], v[54:55], v[78:79]
    v_pk_add_f32 v[56:57], v[56:57], v[200:201]
    v_pk_add_f32 v[58:59], v[58:59], v[202:203]
    v_cvt_pk_bf16_f32 v128, v48, v49
    v_cvt_pk_bf16_f32 v129, v50, v51
    v_cvt_pk_bf16_f32 v130, v52, v53
    v_cvt_pk_bf16_f32 v131, v54, v55
    s_cmp_eq_u32 s73, s74
    s_cbranch_scc0 L_far
    buffer_store_dwordx4 v[128:131], v6, s[32:35], s28 offen
    v_pk_add_f32 v[60:61], v[60:61], v[204:205]
    v_pk_add_f32 v[62:63], v[62:63], v[206:207]
    v_cvt_pk_bf16_f32 v132, v56, v57
    v_cvt_pk_bf16_f32 v133, v58, v59
    v_cvt_pk_bf16_f32 v134, v60, v61
    v_cvt_pk_bf16_f32 v135, v62, v63
    buffer_store_dwordx4 v[132:135], v6, s[32:35], s28 offen offset:1024
    s_waitcnt lgkmcnt(0)
    s_nop 0
    v_pk_add_f32 v[64:65], v[64:65], v[144:145]
    v_pk_add_f32 v[66:67], v[66:67], v[146:147]
    v_pk_add_f32 v[64:65], v[64:65], v[68:69]
    v_pk_add_f32 v[66:67], v[66:67], v[70:71]
    v_pk_add_f32 v[64:65], v[64:65], v[108:109]
    v_pk_add_f32 v[66:67], v[66:67], v[110:111]
    v_cvt_pk_bf16_f32 v136, v64, v65
    v_cvt_pk_bf16_f32 v137, v66, v67
    buffer_store_dwordx4 v[136:139], v6, s[12:15], s52 offen
L_sent:
    s_cmp_eq_u32 s50, 0
    s_cbranch_scc1 L_fin
    ds_write_b128 v250, a[88:91] offset:4096
    s_lshl_b32 s52, s3, 12
    s_add_u32 s52, s52, s62
    s_add_u32 s52, s52, 98304
    v_add_u32 v78, s52, v6
    s_lshl_b32 s52, s3, 9
    s_add_u32 s52, s52, 102400
    v_add_u32 v79, s52, v246
    s_lshl_b32 s52, s4, 12
    ds_write_b128 v250, a[92:95] offset:5120
    s_add_u32 s52, s52, 98304
    v_add_u32_e64 v10, s52, v6
    v_xor_b32 v11, 4096, v10
    s_lshl_b32 s52, s4, 9
    s_add_u32 s52, s52, 102400
    v_add_u32 v12, s52, v246
    v_xor_b32 v13, 512, v12
    v_subrev_u32 v231, 73728, v231
    ds_write_b128 v250, a[96:99] offset:6144
    v_subrev_u32 v249, 73728, v249
    s_waitcnt vmcnt(6)
    v_swap_b32 v26, v16
    v_swap_b32 v27, v17
    v_swap_b32 v30, v20
    v_swap_b32 v31, v21
    v_lshlrev_b32 v48, 16, v80
    v_and_b32 v49, 0xffff0000, v80
    ds_write_b128 v250, a[100:103] offset:7168
    v_mfma_f32_16x16x32_bf16 v[156:159], v[112:115], v[32:35], 0
    v_lshlrev_b32_e64 v50, 16, v81
    v_and_b32 v51, 0xffff0000, v81
    v_mfma_f32_16x16x32_bf16 v[140:143], v[90:93], v[24:27], 0
    buffer_load_dwordx4 a[36:39], v6, s[12:15], s67 offen offset:0
    v_mfma_f32_16x16x32_bf16 v[144:147], v[252:255], v[16:19], 0
    v_lshlrev_b32_e64 v52, 16, v82
    v_and_b32 v53, 0xffff0000, v82
    ds_write_b128 v250, a[104:107] offset:8192
    v_mfma_f32_16x16x32_bf16 v[148:151], v[96:99], v[28:31], 0
    buffer_load_dwordx4 a[40:43], v6, s[12:15], s67 offen offset:1024
    v_mfma_f32_16x16x32_bf16 v[152:155], v[100:103], v[20:23], 0
    v_lshlrev_b32_e64 v54, 16, v83
    v_and_b32 v55, 0xffff0000, v83
    v_mfma_f32_16x16x16_bf16 v[156:159], v[94:95], v[44:45], v[156:159]
    buffer_load_dwordx4 a[44:47], v6, s[12:15], s67 offen offset:2048
    v_mfma_f32_16x16x16_bf16 v[140:143], v[116:117], v[36:37], v[140:143]
    ds_write_b128 v247, a[108:111] offset:40960
    v_lshlrev_b32_e64 v56, 16, v84
    v_and_b32 v57, 0xffff0000, v84
    v_mfma_f32_16x16x16_bf16 v[144:147], v[118:119], v[38:39], v[144:147]
    buffer_load_dwordx4 a[48:51], v6, s[12:15], s67 offen offset:3072
    v_mfma_f32_16x16x16_bf16 v[148:151], v[104:105], v[40:41], v[148:151]
    v_lshlrev_b32_e64 v58, 16, v85
    v_and_b32 v59, 0xffff0000, v85
    v_mfma_f32_16x16x16_bf16 v[152:155], v[106:107], v[42:43], v[152:155]
    ds_write_b128 v247, a[112:115] offset:41984
    buffer_load_dwordx2 v[226:227], v246, s[12:15], s67 offen
    v_lshlrev_b32_e64 v60, 16, v86
    v_and_b32 v61, 0xffff0000, v86
    v_lshlrev_b32_e64 v62, 16, v87
    v_and_b32 v63, 0xffff0000, v87
    v_lshlrev_b32_e64 v64, 16, v88
    v_and_b32 v65, 0xffff0000, v88
    v_lshlrev_b32_e64 v66, 16, v89
    ds_write_b128 v247, a[116:119] offset:43008
    v_and_b32 v67, 0xffff0000, v89
    v_and_b32 v37, 0xf0, v6
    v_add_u32 v36, s60, v37
    s_nop 1
    v_pk_mul_f32 v[140:141], v[140:141], v[48:49]
    v_pk_mul_f32 v[142:143], v[142:143], v[50:51]
    v_pk_mul_f32 v[144:145], v[144:145], v[52:53]
    v_pk_mul_f32 v[146:147], v[146:147], v[54:55]
    ds_write_b128 v247, a[120:123] offset:44032
    v_pk_mul_f32 v[148:149], v[148:149], v[56:57]
    v_pk_mul_f32 v[150:151], v[150:151], v[58:59]
    v_pk_mul_f32 v[152:153], v[152:153], v[60:61]
    v_pk_mul_f32 v[154:155], v[154:155], v[62:63]
    v_pk_mul_f32 v[156:157], v[156:157], v[64:65]
    v_pk_mul_f32 v[158:159], v[158:159], v[66:67]
    v_cvt_pk_bf16_f32 v68, v140, v141
    v_cvt_pk_bf16_f32 v69, v142, v143
    s_mov_b64 exec, s[38:39]
    ds_write_b128 v247, a[140:143] offset:45056
    s_mov_b64 exec, -1
    v_cvt_pk_bf16_f32 v70, v144, v145
    v_cvt_pk_bf16_f32 v71, v146, v147
    v_cvt_pk_bf16_f32 v72, v148, v149
    v_cvt_pk_bf16_f32 v73, v150, v151
    v_cvt_pk_bf16_f32 v74, v152, v153
    v_cvt_pk_bf16_f32 v75, v154, v155
    v_cvt_pk_bf16_f32 v76, v156, v157
    v_cvt_pk_bf16_f32 v77, v158, v159
    ds_write_b128 v78, v[68:71] offset:49152
    v_accvgpr_read_b32 v48, a124
    v_accvgpr_read_b32 v49, a125
    v_accvgpr_read_b32 v50, a126
    v_accvgpr_read_b32 v51, a127
    v_accvgpr_read_b32 v52, a128
    v_accvgpr_read_b32 v53, a129
    ds_write_b128 v78, v[72:75] offset:50176
    v_accvgpr_read_b32 v54, a130
    v_accvgpr_read_b32 v55, a131
    v_accvgpr_read_b32 v56, a132
    v_accvgpr_read_b32 v57, a133
    v_accvgpr_read_b32 v58, a134
    v_accvgpr_read_b32 v59, a135
    s_mov_b64 exec, s[38:39]
    ds_write_b64 v79, v[76:77] offset:49152
    s_mov_b64 exec, -1
    buffer_load_dwordx4 v[164:167], v6, s[32:35], s29 offen sc1
    buffer_load_dwordx4 v[168:171], v6, s[32:35], s29 offen offset:1024 sc1
    buffer_load_dwordx4 v[252:255], v7, s[12:15], s64 offen sc1
    v_accvgpr_read_b32 v60, a136
    v_accvgpr_read_b32 v61, a137
    v_accvgpr_read_b32 v62, a138
    v_accvgpr_read_b32 v63, a139
    v_accvgpr_read_b32 v64, a140
    v_accvgpr_read_b32 v65, a141
    v_accvgpr_read_b32 v66, a142
    v_accvgpr_read_b32 v67, a143
    s_waitcnt lgkmcnt(0)
    s_barrier
    s_waitcnt vmcnt(11)
    ds_read_b128 v[100:103], v10 offset:49152
    v_lshlrev_b32 v80, 16, v192
    v_and_b32 v81, 0xffff0000, v192
    ds_read_b128 v[120:123], v11 offset:49152
    v_lshlrev_b32_e64 v82, 16, v193
    v_and_b32 v83, 0xffff0000, v193
    ds_read_b128 v[104:107], v10 offset:50176
    v_lshlrev_b32_e64 v84, 16, v196
    v_and_b32 v85, 0xffff0000, v196
    ds_read_b128 v[124:127], v11 offset:50176
    v_lshlrev_b32_e64 v86, 16, v197
    v_and_b32 v87, 0xffff0000, v197
    ds_read_b128 v[108:111], v10 offset:51200
    v_lshlrev_b32_e64 v88, 16, v194
    v_and_b32 v89, 0xffff0000, v194
    ds_read_b128 v[180:183], v11 offset:51200
    v_lshlrev_b32_e64 v90, 16, v195
    v_and_b32 v91, 0xffff0000, v195
    ds_read_b128 v[112:115], v10 offset:52224
    v_lshlrev_b32_e64 v92, 16, v198
    v_and_b32 v93, 0xffff0000, v198
    ds_read_b128 v[184:187], v11 offset:52224
    v_lshlrev_b32_e64 v94, 16, v199
    v_and_b32 v95, 0xffff0000, v199
    ds_read_b64 v[116:117], v12 offset:49152
    v_lshlrev_b32_e64 v96, 16, v46
    v_and_b32 v97, 0xffff0000, v46
    ds_read_b64 v[176:177], v13 offset:49152
    v_lshlrev_b32_e64 v98, 16, v47
    v_and_b32 v99, 0xffff0000, v47
    s_waitcnt lgkmcnt(8)
    s_nop 0
    v_mfma_f32_16x16x32_bf16 v[80:83], a[216:219], v[100:103], v[80:83]
    ds_read_b128 v[128:131], v230 offset:4096
    v_mfma_f32_16x16x32_bf16 v[84:87], a[216:219], v[120:123], v[84:87]
    ds_read_b128 v[132:135], v230 offset:5120
    v_mfma_f32_16x16x32_bf16 v[88:91], a[232:235], v[100:103], v[88:91]
    ds_read_b128 v[136:139], v230 offset:6144
    v_mfma_f32_16x16x32_bf16 v[92:95], a[232:235], v[120:123], v[92:95]
    ds_read_b128 v[140:143], v230 offset:7168
    v_mfma_f32_16x16x32_bf16 v[96:99], v[208:211], v[100:103], v[96:99]
    ds_read_b128 v[148:151], v231 offset:4096
    s_waitcnt lgkmcnt(11)
    s_nop 0
    v_mfma_f32_16x16x32_bf16 v[80:83], a[220:223], v[104:107], v[80:83]
    ds_read_b128 v[152:155], v231 offset:5120
    v_mfma_f32_16x16x32_bf16 v[84:87], a[220:223], v[124:127], v[84:87]
    ds_read_b128 v[156:159], v231 offset:6144
    v_mfma_f32_16x16x32_bf16 v[88:91], a[236:239], v[104:107], v[88:91]
    ds_read_b128 v[160:163], v231 offset:7168
    v_mfma_f32_16x16x32_bf16 v[92:95], a[236:239], v[124:127], v[92:95]
    s_waitcnt lgkmcnt(4)
    ds_read_b128 v[16:19], v249 offset:0
    v_add_f32 v48, v48, v128
    v_mfma_f32_16x16x32_bf16 v[96:99], v[212:215], v[104:107], v[96:99]
    ds_read_b128 v[20:23], v249 offset:1024
    v_add_f32 v49, v49, v129
    s_waitcnt lgkmcnt(14)
    v_mfma_f32_16x16x32_bf16 v[80:83], a[224:227], v[108:111], v[80:83]
    ds_read_b128 v[24:27], v249 offset:2048
    v_add_f32_e64 v50, v50, v130
    v_mfma_f32_16x16x32_bf16 v[84:87], a[224:227], v[180:183], v[84:87]
    ds_read_b128 v[28:31], v249 offset:3072
    v_add_f32_e64 v51, v51, v131
    v_mfma_f32_16x16x32_bf16 v[88:91], a[240:243], v[108:111], v[88:91]
    s_not_b64 exec, s[38:39]
    ds_read_b128 v[144:147], v230 offset:8192
    ds_read_b128 v[188:191], v231 offset:8192
    ds_read_b128 v[32:35], v249 offset:8192
    s_mov_b64 exec, -1
    v_add_f32_e64 v52, v52, v132
    v_mfma_f32_16x16x32_bf16 v[92:95], a[240:243], v[180:183], v[92:95]
    ds_read_b128 v[36:39], v36 offset:512
    v_add_f32_e64 v53, v53, v133
    v_mfma_f32_16x16x32_bf16 v[96:99], v[216:219], v[108:111], v[96:99]
    v_add_f32 v54, v54, v134
    v_add_f32_e64 v55, v55, v135
    s_waitcnt lgkmcnt(15)
    v_mfma_f32_16x16x32_bf16 v[80:83], a[228:231], v[112:115], v[80:83]
    v_add_f32 v56, v56, v136
    v_add_f32 v57, v57, v137
    v_mfma_f32_16x16x32_bf16 v[84:87], a[228:231], v[184:187], v[84:87]
    s_waitcnt lgkmcnt(8)
    v_add_f32 v58, v58, v138
    v_add_f32_e64 v59, v59, v139
    v_mfma_f32_16x16x32_bf16 v[88:91], a[244:247], v[112:115], v[88:91]
    v_add_f32 v60, v60, v140
    v_add_f32 v61, v61, v141
    v_mfma_f32_16x16x32_bf16 v[92:95], a[244:247], v[184:187], v[92:95]
    v_add_f32 v62, v62, v142
    v_add_f32 v63, v63, v143
    v_mfma_f32_16x16x32_bf16 v[96:99], v[220:223], v[112:115], v[96:99]
    v_add_f32 v48, v48, v148
    v_add_f32 v49, v49, v149
    v_pk_add_f32 v[50:51], v[50:51], v[150:151]
    v_pk_add_f32 v[52:53], v[52:53], v[152:153]
    v_pk_add_f32 v[54:55], v[54:55], v[154:155]
    v_pk_add_f32 v[56:57], v[56:57], v[156:157]
    v_pk_add_f32 v[58:59], v[58:59], v[158:159]
    v_pk_add_f32 v[60:61], v[60:61], v[160:161]
    v_pk_add_f32 v[62:63], v[62:63], v[162:163]
    s_waitcnt lgkmcnt(0)
    s_nop 0
    v_pk_add_f32 v[48:49], v[48:49], v[16:17]
    v_pk_add_f32 v[50:51], v[50:51], v[18:19]
    v_pk_add_f32 v[52:53], v[52:53], v[20:21]
    v_pk_add_f32 v[54:55], v[54:55], v[22:23]
    v_pk_add_f32 v[56:57], v[56:57], v[24:25]
    v_pk_add_f32 v[58:59], v[58:59], v[26:27]
    v_pk_add_f32 v[60:61], v[60:61], v[28:29]
    v_pk_add_f32 v[62:63], v[62:63], v[30:31]
    v_add_f32 v36, v36, v37
    v_add_f32 v38, v38, v39
    v_pk_add_f32 v[64:65], v[64:65], v[144:145]
    v_pk_add_f32 v[66:67], v[66:67], v[146:147]
    v_pk_add_f32 v[64:65], v[64:65], v[188:189]
    v_pk_add_f32 v[66:67], v[66:67], v[190:191]
    v_pk_add_f32 v[64:65], v[64:65], v[32:33]
    v_pk_add_f32 v[66:67], v[66:67], v[34:35]
    s_mov_b32 s54, 0
    v_add_f32 v36, v36, v38
    s_mov_b32 s56, 0x3f80
    s_mov_b32 s57, 0x3f800000
    s_waitcnt vmcnt(0)
    v_max3_u32 v46, v164, v165, v166
    v_max3_u32 v47, v167, v168, v169
    v_cmp_neq_f32 s[58:59], v235, v255
    v_max3_u32 v46, v46, v170, v171
    v_max3_u32 v47, v47, v252, v253
    v_max3_u32 v46, v46, v254, v255
    v_add_f32 v40, v36, v254
    v_max_u32 v46, v46, v47
    v_cmp_eq_u32 vcc, -1, v46
    v_rcp_f32 v40, v40
    s_or_b64 vcc, vcc, s[58:59]
    s_cbranch_scc1 L_slow
    v_dot2_f32_bf16 v48, v164, s56, v48
    v_dot2_f32_bf16 v49, v164, s57, v49
    v_dot2_f32_bf16 v50, v165, s56, v50
    v_dot2_f32_bf16 v51, v165, s57, v51
    v_dot2_f32_bf16 v52, v166, s56, v52
    v_dot2_f32_bf16 v53, v166, s57, v53
    v_dot2_f32_bf16 v54, v167, s56, v54
    v_dot2_f32_bf16 v55, v167, s57, v55
    v_dot2_f32_bf16 v56, v168, s56, v56
    v_dot2_f32_bf16 v57, v168, s57, v57
    v_dot2_f32_bf16 v58, v169, s56, v58
    v_dot2_f32_bf16 v59, v169, s57, v59
    v_dot2_f32_bf16 v60, v170, s56, v60
    v_dot2_f32_bf16 v61, v170, s57, v61
    v_dot2_f32_bf16 v62, v171, s56, v62
    v_dot2_f32_bf16 v63, v171, s57, v63
    v_dot2_f32_bf16 v64, v252, s56, v64
    v_dot2_f32_bf16 v65, v252, s57, v65
    v_dot2_f32_bf16 v66, v253, s56, v66
    v_dot2_f32_bf16 v67, v253, s57, v67
    v_pk_mul_f32 v[48:49], v[48:49], v[40:41] op_sel_hi:[1,0]
    v_pk_mul_f32 v[50:51], v[50:51], v[40:41] op_sel_hi:[1,0]
    v_pk_mul_f32 v[52:53], v[52:53], v[40:41] op_sel_hi:[1,0]
    v_pk_mul_f32 v[54:55], v[54:55], v[40:41] op_sel_hi:[1,0]
    v_pk_mul_f32 v[56:57], v[56:57], v[40:41] op_sel_hi:[1,0]
    v_pk_mul_f32 v[58:59], v[58:59], v[40:41] op_sel_hi:[1,0]
    v_pk_mul_f32 v[60:61], v[60:61], v[40:41] op_sel_hi:[1,0]
    v_pk_mul_f32 v[62:63], v[62:63], v[40:41] op_sel_hi:[1,0]
    v_pk_mul_f32 v[64:65], v[64:65], v[40:41] op_sel_hi:[1,0]
    v_pk_mul_f32 v[66:67], v[66:67], v[40:41] op_sel_hi:[1,0]
L_mrg:
    v_cvt_pk_bf16_f32 v68, v48, v49
    v_cvt_pk_bf16_f32 v69, v50, v51
    v_cvt_pk_bf16_f32 v70, v52, v53
    v_cvt_pk_bf16_f32 v71, v54, v55
    ds_write_b128 v78, v[68:71]
    v_cvt_pk_bf16_f32 v72, v56, v57
    v_cvt_pk_bf16_f32 v73, v58, v59
    v_cvt_pk_bf16_f32 v74, v60, v61
    v_cvt_pk_bf16_f32 v75, v62, v63
    ds_write_b128 v78, v[72:75] offset:1024
    v_cvt_pk_bf16_f32 v76, v64, v65
    v_cvt_pk_bf16_f32 v77, v66, v67
    s_not_b64 exec, s[38:39]
    ds_write_b64 v79, v[76:77]
    s_mov_b64 exec, -1
    s_waitcnt lgkmcnt(0)
    s_barrier
    ds_read_b128 v[128:131], v10 offset:0
    ds_read_b128 v[132:135], v10 offset:1024
    ds_read_b128 v[136:139], v10 offset:2048
    ds_read_b128 v[140:143], v10 offset:3072
    ds_read_b64 v[118:119], v12 offset:0
    ds_read_b128 v[146:149], v11 offset:0
    ds_read_b128 v[150:153], v11 offset:1024
    ds_read_b128 v[154:157], v11 offset:2048
    ds_read_b128 v[158:161], v11 offset:3072
    ds_read_b64 v[178:179], v13 offset:0
    s_waitcnt lgkmcnt(9)
    v_mfma_f32_16x16x32_bf16 v[80:83], a[0:3], v[128:131], v[80:83]
    v_mfma_f32_16x16x32_bf16 v[88:91], a[18:21], v[128:131], v[88:91]
    s_waitcnt lgkmcnt(8)
    v_mfma_f32_16x16x32_bf16 v[80:83], a[4:7], v[132:135], v[80:83]
    v_mfma_f32_16x16x32_bf16 v[88:91], a[22:25], v[132:135], v[88:91]
    s_waitcnt lgkmcnt(7)
    v_mfma_f32_16x16x32_bf16 v[80:83], a[8:11], v[136:139], v[80:83]
    v_mfma_f32_16x16x32_bf16 v[88:91], a[26:29], v[136:139], v[88:91]
    s_waitcnt lgkmcnt(6)
    v_mfma_f32_16x16x32_bf16 v[80:83], a[12:15], v[140:143], v[80:83]
    v_mfma_f32_16x16x32_bf16 v[88:91], a[30:33], v[140:143], v[88:91]
    s_waitcnt lgkmcnt(5)
    v_mfma_f32_16x16x32_bf16 v[80:83], a[248:251], v[116:119], v[80:83]
    v_mfma_f32_16x16x32_bf16 v[88:91], a[252:255], v[116:119], v[88:91]
    s_waitcnt lgkmcnt(4)
    v_mfma_f32_16x16x32_bf16 v[84:87], a[0:3], v[146:149], v[84:87]
    v_mfma_f32_16x16x32_bf16 v[92:95], a[18:21], v[146:149], v[92:95]
    s_waitcnt lgkmcnt(3)
    v_mfma_f32_16x16x32_bf16 v[84:87], a[4:7], v[150:153], v[84:87]
    v_mfma_f32_16x16x32_bf16 v[92:95], a[22:25], v[150:153], v[92:95]
    s_waitcnt lgkmcnt(2)
    v_mfma_f32_16x16x32_bf16 v[84:87], a[8:11], v[154:157], v[84:87]
    v_mfma_f32_16x16x32_bf16 v[92:95], a[26:29], v[154:157], v[92:95]
    v_cvt_pk_bf16_f32 v16, v80, v81
    s_waitcnt lgkmcnt(1)
    s_nop 0
    v_mfma_f32_16x16x32_bf16 v[84:87], a[12:15], v[158:161], v[84:87]
    v_cvt_pk_bf16_f32 v17, v82, v83
    v_mfma_f32_16x16x32_bf16 v[92:95], a[30:33], v[158:161], v[92:95]
    v_cvt_pk_bf16_f32 v18, v88, v89
    s_waitcnt lgkmcnt(0)
    s_nop 0
    v_mfma_f32_16x16x32_bf16 v[84:87], a[248:251], v[176:179], v[84:87]
    v_cvt_pk_bf16_f32 v19, v90, v91
    v_mfma_f32_16x16x32_bf16 v[92:95], a[252:255], v[176:179], v[92:95]
    buffer_store_dwordx4 v[16:19], v236, s[32:35], s43 offen
    s_cmp_ge_u32 s40, 2
    s_cbranch_scc1 L_fin23
    v_mfma_f32_16x16x32_bf16 v[96:99], a[36:39], v[128:131], v[96:99]
    v_mfma_f32_16x16x32_bf16 v[96:99], a[40:43], v[132:135], v[96:99]
    v_mfma_f32_16x16x32_bf16 v[96:99], a[44:47], v[136:139], v[96:99]
    v_mfma_f32_16x16x32_bf16 v[96:99], a[48:51], v[140:143], v[96:99]
    v_mfma_f32_16x16x32_bf16 v[96:99], v[224:227], v[116:119], v[96:99]
    v_cvt_pk_bf16_f32 v20, v84, v85
    v_cvt_pk_bf16_f32 v21, v86, v87
    v_cvt_pk_bf16_f32 v22, v92, v93
    v_cvt_pk_bf16_f32 v23, v94, v95
    buffer_store_dwordx4 v[20:23], v237, s[32:35], s43 offen
    s_nop 2
    v_cvt_pk_bf16_f32 v24, v96, v97
    v_cvt_pk_bf16_f32 v25, v98, v99
    buffer_store_dwordx2 v[24:25], v9, s[32:35], 0 offen offset:256
L_fin:
L_end:
    s_endpgm
L_fin23:
    s_nop 4
    s_nop 0
    v_cvt_pk_bf16_f32 v20, v84, v85
    v_cvt_pk_bf16_f32 v21, v86, v87
    v_cvt_pk_bf16_f32 v22, v92, v93
    v_cvt_pk_bf16_f32 v23, v94, v95
    buffer_store_dwordx4 v[20:23], v237, s[32:35], s43 offen
    s_endpgm
L_slow:
    s_branch L_poll3
L_got:
    s_nop 0
    s_nop 0
    v_pk_mul_f32 v[48:49], v[48:49], v[40:41] op_sel_hi:[1,0]
    v_pk_mul_f32 v[50:51], v[50:51], v[40:41] op_sel_hi:[1,0]
    v_pk_mul_f32 v[52:53], v[52:53], v[40:41] op_sel_hi:[1,0]
    v_pk_mul_f32 v[54:55], v[54:55], v[40:41] op_sel_hi:[1,0]
    v_pk_mul_f32 v[56:57], v[56:57], v[40:41] op_sel_hi:[1,0]
    v_pk_mul_f32 v[58:59], v[58:59], v[40:41] op_sel_hi:[1,0]
    v_pk_mul_f32 v[60:61], v[60:61], v[40:41] op_sel_hi:[1,0]
    v_pk_mul_f32 v[62:63], v[62:63], v[40:41] op_sel_hi:[1,0]
    v_pk_mul_f32 v[64:65], v[64:65], v[40:41] op_sel_hi:[1,0]
    v_pk_mul_f32 v[66:67], v[66:67], v[40:41] op_sel_hi:[1,0]
    v_pk_fma_f32 v[48:49], v[128:129], v[42:43], v[48:49] op_sel_hi:[1,0,1]
    v_pk_fma_f32 v[50:51], v[130:131], v[42:43], v[50:51] op_sel_hi:[1,0,1]
    v_pk_fma_f32 v[52:53], v[132:133], v[42:43], v[52:53] op_sel_hi:[1,0,1]
    v_pk_fma_f32 v[54:55], v[134:135], v[42:43], v[54:55] op_sel_hi:[1,0,1]
    v_pk_fma_f32 v[56:57], v[136:137], v[42:43], v[56:57] op_sel_hi:[1,0,1]
    v_pk_fma_f32 v[58:59], v[138:139], v[42:43], v[58:59] op_sel_hi:[1,0,1]
    v_pk_fma_f32 v[60:61], v[140:141], v[42:43], v[60:61] op_sel_hi:[1,0,1]
    v_pk_fma_f32 v[62:63], v[142:143], v[42:43], v[62:63] op_sel_hi:[1,0,1]
    v_pk_fma_f32 v[64:65], v[144:145], v[42:43], v[64:65] op_sel_hi:[1,0,1]
    v_pk_fma_f32 v[66:67], v[146:147], v[42:43], v[66:67] op_sel_hi:[1,0,1]
    s_branch L_mrg
L_poll2:
    buffer_load_dwordx4 v[164:167], v6, s[32:35], s29 offen sc1
    buffer_load_dwordx4 v[168:171], v6, s[32:35], s29 offen offset:1024 sc1
    buffer_load_dwordx4 v[252:255], v7, s[12:15], s64 offen sc1
L_poll3:
    s_waitcnt vmcnt(0)
    v_max3_u32 v46, v164, v165, v166
    v_max3_u32 v47, v167, v168, v169
    v_max3_u32 v46, v46, v170, v171
    v_max3_u32 v47, v47, v252, v253
    v_max3_u32 v46, v46, v254, v255
    v_max_u32_e64 v46, v46, v47
    v_cmp_eq_u32 vcc, -1, v46
    s_add_u32 s54, s54, 1
    s_cmp_eq_u64 vcc, 0
    s_cbranch_scc1 L_take1
    buffer_load_dwordx4 v[164:167], v6, s[32:35], s29 offen sc1
    buffer_load_dwordx4 v[168:171], v6, s[32:35], s29 offen offset:1024 sc1
    buffer_load_dwordx4 v[252:255], v7, s[12:15], s64 offen sc1
    s_cmp_lt_u32 s54, 0x30000
    s_cbranch_scc1 L_poll3
    s_waitcnt vmcnt(0)
L_take1:
    v_min_f32 v40, v235, v255
    v_lshlrev_b32 v128, 16, v164
    v_and_b32 v129, 0xffff0000, v164
    v_sub_f32 v42, v40, v255
    v_lshlrev_b32 v130, 16, v165
    v_and_b32 v131, 0xffff0000, v165
    v_sub_f32 v40, v40, v235
    v_lshlrev_b32 v132, 16, v166
    v_and_b32 v133, 0xffff0000, v166
    v_exp_f32 v42, v42
    v_lshlrev_b32 v134, 16, v167
    v_and_b32 v135, 0xffff0000, v167
    v_exp_f32 v40, v40
    v_lshlrev_b32 v136, 16, v168
    v_and_b32 v137, 0xffff0000, v168
    v_mul_f32 v44, v42, v254
    v_lshlrev_b32 v138, 16, v169
    v_and_b32 v139, 0xffff0000, v169
    v_fmac_f32 v44, v40, v36
    v_lshlrev_b32 v140, 16, v170
    v_and_b32 v141, 0xffff0000, v170
    v_rcp_f32 v44, v44
    v_lshlrev_b32 v142, 16, v171
    v_and_b32 v143, 0xffff0000, v171
    v_mul_f32 v40, v40, v44
    v_lshlrev_b32 v144, 16, v252
    v_and_b32 v145, 0xffff0000, v252
    v_mul_f32 v42, v42, v44
    v_lshlrev_b32 v146, 16, v253
    v_and_b32 v147, 0xffff0000, v253
    s_branch L_got
L_far:
    s_nop 0
    buffer_store_dwordx4 v[128:131], v6, s[32:35], s28 offen sc1
    v_pk_add_f32 v[60:61], v[60:61], v[204:205]
    v_pk_add_f32 v[62:63], v[62:63], v[206:207]
    v_cvt_pk_bf16_f32 v132, v56, v57
    v_cvt_pk_bf16_f32 v133, v58, v59
    v_cvt_pk_bf16_f32 v134, v60, v61
    v_cvt_pk_bf16_f32 v135, v62, v63
    buffer_store_dwordx4 v[132:135], v6, s[32:35], s28 offen offset:1024 sc1
    s_waitcnt lgkmcnt(0)
    s_nop 0
    v_pk_add_f32 v[64:65], v[64:65], v[144:145]
    v_pk_add_f32 v[66:67], v[66:67], v[146:147]
    v_pk_add_f32 v[64:65], v[64:65], v[68:69]
    v_pk_add_f32 v[66:67], v[66:67], v[70:71]
    v_pk_add_f32 v[64:65], v[64:65], v[108:109]
    v_pk_add_f32 v[66:67], v[66:67], v[110:111]
    v_cvt_pk_bf16_f32 v136, v64, v65
    v_cvt_pk_bf16_f32 v137, v66, v67
    buffer_store_dwordx4 v[136:139], v6, s[12:15], s52 offen sc1
    s_branch L_sent
L_ga:
    s_mov_b32 s54, 0
L_ga2:
    s_sleep 4
    buffer_load_dword v252, v249, s[12:15], s75 offen sc1
    s_add_u32 s54, s54, 1
    s_waitcnt vmcnt(0)
    v_cmp_ne_u32 vcc, s98, v252
    s_and_b64 vcc, vcc, s[60:61]
    s_cbranch_scc0 L_ga_ok
    s_cmp_lt_u32 s54, 0x40000
    s_cbranch_scc1 L_ga2
    s_branch L_ga_ok
L_no15:
    ds_read_b64_tr_b16 v[164:165], v202 offset:0
    ds_read_b64_tr_b16 v[166:167], v202 offset:256
    ds_read_b64_tr_b16 v[168:169], v203 offset:0
    ds_read_b64_tr_b16 v[170:171], v203 offset:256
    ds_read_b64_tr_b16 v[172:173], v202 offset:2048
    ds_read_b64_tr_b16 v[174:175], v202 offset:2304
    v_exp_f32_e64 v30, v30
    ds_read_b64_tr_b16 v[176:177], v203 offset:2048
    v_cvt_pk_bf16_f32 v100, v24, v25
    ds_read_b64_tr_b16 v[178:179], v203 offset:2304
    v_exp_f32_e64 v31, v31
    ds_read_b64_tr_b16 v[180:181], v205 offset:0
    v_cvt_pk_bf16_f32 v101, v26, v27
    ds_read_b64_tr_b16 v[182:183], v205 offset:256
    v_exp_f32_e64 v32, v32
    ds_read_b64_tr_b16 v[184:185], v206 offset:0
    v_cvt_pk_bf16_f32 v102, v28, v29
    ds_read_b64_tr_b16 v[186:187], v206 offset:256
    v_exp_f32_e64 v33, v33
    ds_read_b64_tr_b16 v[188:189], v205 offset:2048
    v_cvt_pk_bf16_f32 v103, v30, v31
    ds_read_b64_tr_b16 v[190:191], v205 offset:2304
    v_exp_f32_e64 v34, v34
    ds_read_b64_tr_b16 v[192:193], v206 offset:2048
    v_cvt_pk_bf16_f32 v104, v32, v33
    ds_read_b64_tr_b16 v[194:195], v206 offset:2304
    v_exp_f32_e64 v35, v35
    ds_read_b64_tr_b16 v[196:197], v204 offset:8192
    v_exp_f32_e64 v36, v36
    ds_read_b64_tr_b16 v[198:199], v204 offset:8704
    v_cvt_pk_bf16_f32 v105, v34, v35
    s_waitcnt vmcnt(9)
    v_exp_f32 v37, v37
    ds_read_b128 a[216:219], v250 offset:0
    v_exp_f32_e64 v38, v38
    buffer_load_dwordx4 v[208:211], v6, s[12:15], s66 offen offset:0
    v_cvt_pk_bf16_f32 v106, v36, v37
    ds_read_b128 a[220:223], v250 offset:1024
    v_exp_f32_e64 v39, v39
    ds_read_b128 a[224:227], v250 offset:2048
    v_exp_f32_e64 v40, v40
    buffer_load_dwordx4 v[212:215], v6, s[12:15], s66 offen offset:1024
    v_cvt_pk_bf16_f32 v107, v38, v39
    ds_read_b128 a[228:231], v250 offset:3072
    v_exp_f32_e64 v41, v41
    ds_read_b64 a[248:249], v251 offset:0
    v_exp_f32_e64 v42, v42
    buffer_load_dwordx4 v[216:219], v6, s[12:15], s66 offen offset:2048
    v_cvt_pk_bf16_f32 v108, v40, v41
    ds_read_b128 a[232:235], v250 offset:4608
    v_exp_f32_e64 v43, v43
    ds_read_b128 a[236:239], v250 offset:5632
    v_exp_f32_e64 v44, v44
    buffer_load_dwordx4 v[220:223], v6, s[12:15], s66 offen offset:3072
    v_cvt_pk_bf16_f32 v109, v42, v43
    ds_read_b128 a[240:243], v250 offset:6656
    v_exp_f32_e64 v45, v45
    ds_read_b128 a[244:247], v250 offset:7680
    v_exp_f32_e64 v46, v46
    buffer_load_dwordx2 v[224:225], v246, s[12:15], s66 offen
    v_cvt_pk_bf16_f32 v110, v44, v45
    ds_read_b64 a[252:253], v251 offset:4608
    v_exp_f32 v47, v47
    s_nop 0
    v_cvt_pk_bf16_f32 v111, v46, v47
    s_waitcnt lgkmcnt(0)
    s_nop 1
    v_mfma_f32_16x16x32_bf16 a[0:3], v[164:167], v[96:99], a[0:3]
    buffer_load_dwordx4 v[24:27], v240, s[12:15], s6 offen offset:0
    v_mfma_f32_16x16x32_bf16 a[4:7], v[168:171], v[96:99], a[4:7]
    buffer_load_dwordx4 v[28:31], v240, s[12:15], s6 offen offset:1024
    v_mfma_f32_16x16x32_bf16 a[8:11], v[172:175], v[96:99], a[8:11]
    v_mfma_f32_16x16x32_bf16 a[12:15], v[176:179], v[96:99], a[12:15]
    buffer_load_dwordx2 v[32:33], v241, s[12:15], s6 offen
    v_mfma_f32_16x16x32_bf16 a[16:19], v[180:183], v[96:99], a[16:19]
    buffer_load_dwordx4 v[16:19], v238, s[12:15], s6 offen offset:0
    v_mfma_f32_16x16x32_bf16 a[20:23], v[184:187], v[96:99], a[20:23]
    ds_write_b128 v247, a[0:3] offset:0
    v_mfma_f32_16x16x32_bf16 a[24:27], v[188:191], v[96:99], a[24:27]
    ds_write_b128 v247, a[4:7] offset:1024
    buffer_load_dwordx4 v[20:23], v238, s[12:15], s6 offen offset:1024
    v_mfma_f32_16x16x32_bf16 a[28:31], v[192:195], v[96:99], a[28:31]
    buffer_load_dwordx2 v[34:35], v239, s[12:15], s6 offen
    v_mfma_f32_16x16x32_bf16 a[32:35], v[196:199], v[96:99], a[32:35]
    ds_write_b128 v247, a[8:11] offset:2048
    v_mfma_f32_16x16x32_bf16 a[36:39], v[164:167], v[100:103], a[36:39]
    ds_write_b128 v247, a[12:15] offset:3072
    buffer_load_dwordx4 v[36:39], v242, s[12:15], s6 offen offset:0
    v_mfma_f32_16x16x32_bf16 a[40:43], v[168:171], v[100:103], a[40:43]
    buffer_load_dwordx4 v[40:43], v242, s[12:15], s6 offen offset:1024
    v_mfma_f32_16x16x32_bf16 a[44:47], v[172:175], v[100:103], a[44:47]
    ds_write_b128 v247, a[16:19] offset:4096
    v_mfma_f32_16x16x32_bf16 a[48:51], v[176:179], v[100:103], a[48:51]
    ds_write_b128 v247, a[20:23] offset:5120
    buffer_load_dwordx2 v[44:45], v243, s[12:15], s6 offen
    v_mfma_f32_16x16x32_bf16 a[68:71], v[196:199], v[100:103], a[68:71]
    buffer_load_dwordx4 v[80:83], v238, s[12:15], s5 offen offset:0
    v_mfma_f32_16x16x32_bf16 a[52:55], v[180:183], v[100:103], a[52:55]
    ds_write_b128 v247, a[24:27] offset:6144
    v_mfma_f32_16x16x32_bf16 a[56:59], v[184:187], v[100:103], a[56:59]
    ds_write_b128 v247, a[28:31] offset:7168
    buffer_load_dwordx4 v[84:87], v238, s[12:15], s5 offen offset:1024
    v_mfma_f32_16x16x32_bf16 a[60:63], v[188:191], v[100:103], a[60:63]
    buffer_load_dwordx2 v[88:89], v239, s[12:15], s5 offen
    v_mfma_f32_16x16x32_bf16 a[64:67], v[192:195], v[100:103], a[64:67]
    ds_write_b128 v247, a[32:35] offset:8192
    s_mov_b64 exec, 0xffff
    ds_write_b32 v245, a32 offset:0
    s_mov_b64 exec, -1
    s_nop 0
    v_mfma_f32_16x16x32_bf16 a[72:75], v[164:167], v[104:107], a[72:75]
    ds_write_b128 v247, a[36:39] offset:36864
    buffer_load_dwordx4 v[90:93], v244, s[12:15], 0 offen offset:0
    v_mfma_f32_16x16x32_bf16 a[76:79], v[168:171], v[104:107], a[76:79]
    buffer_load_dwordx4 v[252:255], v244, s[12:15], 0 offen offset:256
    v_mfma_f32_16x16x32_bf16 a[80:83], v[172:175], v[104:107], a[80:83]
    ds_write_b128 v247, a[40:43] offset:37888
    v_mfma_f32_16x16x32_bf16 a[84:87], v[176:179], v[104:107], a[84:87]
    ds_write_b128 v247, a[44:47] offset:38912
    buffer_load_dwordx4 v[96:99], v244, s[12:15], 0 offen offset:512
    v_mfma_f32_16x16x32_bf16 a[88:91], v[180:183], v[104:107], a[88:91]
    buffer_load_dwordx4 v[100:103], v244, s[12:15], 0 offen offset:768
    v_mfma_f32_16x16x32_bf16 a[92:95], v[184:187], v[104:107], a[92:95]
    ds_write_b128 v247, a[48:51] offset:39936
    v_mfma_f32_16x16x32_bf16 a[96:99], v[188:191], v[104:107], a[96:99]
    s_not_b64 exec, s[38:39]
    ds_write_b128 v247, a[68:71] offset:45056
    s_mov_b64 exec, -1
    buffer_load_dwordx4 v[112:115], v244, s[12:15], 0 offen offset:1024
    v_mfma_f32_16x16x32_bf16 a[100:103], v[192:195], v[104:107], a[100:103]
    buffer_load_dwordx4 v[116:119], v244, s[12:15], 0 offen offset:1280
    v_mfma_f32_16x16x32_bf16 a[104:107], v[196:199], v[104:107], a[104:107]
    ds_write_b128 v250, a[72:75] offset:0
    v_mfma_f32_16x16x32_bf16 a[108:111], v[164:167], v[108:111], a[108:111]
    ds_write_b128 v250, a[76:79] offset:1024
    buffer_load_dwordx4 v[104:107], v244, s[12:15], 0 offen offset:1536
    v_mfma_f32_16x16x32_bf16 a[112:115], v[168:171], v[108:111], a[112:115]
    s_waitcnt vmcnt(19)
    s_nop 0
    ds_read_b128 a[0:3], v250 offset:36864
    v_mfma_f32_16x16x32_bf16 a[116:119], v[172:175], v[108:111], a[116:119]
    ds_write_b128 v250, a[80:83] offset:2048
    v_mfma_f32_16x16x32_bf16 a[120:123], v[176:179], v[108:111], a[120:123]
    ds_write_b128 v250, a[84:87] offset:3072
    v_mfma_f32_16x16x32_bf16 a[140:143], v[196:199], v[108:111], a[140:143]
    ds_read_b128 a[4:7], v250 offset:37888
    v_mfma_f32_16x16x32_bf16 a[124:127], v[180:183], v[108:111], a[124:127]
    ds_read_b128 a[8:11], v250 offset:38912
    v_mfma_f32_16x16x32_bf16 a[128:131], v[184:187], v[108:111], a[128:131]
    ds_read_b128 a[12:15], v250 offset:39936
    v_mfma_f32_16x16x32_bf16 a[132:135], v[188:191], v[108:111], a[132:135]
    ds_read_b64 a[250:251], v251 offset:36864
    v_mfma_f32_16x16x32_bf16 a[136:139], v[192:195], v[108:111], a[136:139]
    ds_read_b128 a[18:21], v250 offset:41472
    ds_read_b128 a[22:25], v250 offset:42496
    ds_read_b128 a[26:29], v250 offset:43520
    ds_read_b128 a[30:33], v250 offset:44544
    ds_read_b64 a[254:255], v251 offset:41472
    s_nop 7
    s_branch L_e1
L_dummy:
L_wfuse:
    s_sub_u32 s2, s2, 252
    s_cmp_ge_u32 s2, 4
    s_cbranch_scc1 L_end
    s_mov_b32 s3, L_wfuse-L_pf
    buffer_load_dwordx4 v[252:255], v2, s[24:27], s3 offen
    v_and_b32 v0, 63, v0
    v_lshlrev_b32 v6, 4, v0
    s_mul_i32 s54, s2, 9216
    v_and_b32_e64 v164, 15, v0
    v_mul_u32_u24 v164, 288, v164
    v_lshrrev_b32_e64 v166, 4, v0
    v_lshl_add_u32 v165, v166, 3, v164
    v_lshl_add_u32 v164, v166, 4, v164
    v_bfe_u32 v166, v0, 2, 1
    v_mul_u32_u24 v166, 4608, v166
    v_sub_u32 v167, 4608, v166
    v_add_u32 v160, v164, v166
    v_add_u32 v161, v165, v166
    v_add_u32 v162, v164, v167
    v_add_u32 v163, v165, v167
    v_lshlrev_b32 v166, 3, v0
    s_and_b32 s52, s2, 1
    s_lshl1_add_u32 s52, s52, s40
    s_and_b32 s52, s52, 3
    s_mul_i32 s53, s52, 9216
    v_add_u32 v184, s53, v160
    v_add_u32 v185, s53, v161
    v_add_u32 v186, s53, v162
    v_add_u32 v187, s53, v163
    v_mov_b32 v246, 0x3df6384f
    s_waitcnt lgkmcnt(0)
    s_mov_b32 s24, s58
    s_mov_b32 s25, s59
    s_mov_b32 s26, 41472
    s_mov_b32 s27, 0x20000
    s_lshl_b32 s58, s40, 10
    s_mov_b32 m0, s58
    s_mov_b32 s59, s58
    buffer_load_dwordx4 v6, s[24:27], s59 offen lds
    s_add_u32 m0, m0, 4096
    s_add_u32 s59, s59, 4096
    buffer_load_dwordx4 v6, s[24:27], s59 offen lds
    s_add_u32 m0, m0, 4096
    s_add_u32 s59, s59, 4096
    buffer_load_dwordx4 v6, s[24:27], s59 offen lds
    s_add_u32 m0, m0, 4096
    s_add_u32 s59, s59, 4096
    buffer_load_dwordx4 v6, s[24:27], s59 offen lds
    s_add_u32 m0, m0, 4096
    s_add_u32 s59, s59, 4096
    buffer_load_dwordx4 v6, s[24:27], s59 offen lds
    s_add_u32 m0, m0, 4096
    s_add_u32 s59, s59, 4096
    s_mov_b32 s28, s60
    s_mov_b32 s29, s61
    s_mov_b32 s30, 41472
    s_mov_b32 s31, 0x20000
    s_mov_b32 s20, s76
    s_mov_b32 s21, s77
    s_mov_b32 s22, 256
    s_mov_b32 s23, 0x20000
    s_mov_b32 s12, s78
    s_mov_b32 s13, s79
    s_mov_b32 s14, 268435456
    s_mov_b32 s15, 0x20000
    s_mov_b32 s8, s78
    s_mov_b32 s9, s79
    s_mov_b32 s10, 2621440
    s_mov_b32 s11, 0x20000
    s_mov_b32 s42, 2.0
    s_mov_b32 s43, 2.0
    s_mov_b32 s44, 2.0
    s_mov_b32 s45, 2.0
    s_mov_b32 s46, 2.0
    s_mov_b32 s47, 2.0
    s_mov_b32 s48, 0x40000
    s_mov_b64 exec, 0
    s_cmp_eq_u32 s40, 1
    s_cbranch_scc1 L_mf0
    s_cmp_eq_u32 s40, 0
    s_cbranch_scc1 L_mfa
    s_cmp_eq_u32 s40, 2
    s_cbranch_scc1 L_mf3
    s_branch L_mfc
L_mf9:
    s_mov_b64 exec, -1
L_mq:
    s_nop 0
    buffer_load_dwordx4 v6, s[24:27], s59 offen lds
    s_add_u32 m0, m0, 4096
    s_add_u32 s59, s59, 4096
    s_cmp_lt_u32 s59, 41472
    s_cbranch_scc1 L_mq
    s_add_u32 m0, s58, 41984
    s_add_u32 s59, s58, s54
    s_add_u32 s55, s54, 9216
L_mk:
    buffer_load_dwordx4 v6, s[28:31], s59 offen lds
    s_add_u32 m0, m0, 4096
    s_add_u32 s59, s59, 4096
    s_cmp_lt_u32 s59, s55
    s_cbranch_scc1 L_mk
    s_add_u32 m0, s58, 51200
    s_add_u32 s59, s58, 36864
L_mk8:
    buffer_load_dwordx4 v6, s[28:31], s59 offen lds
    s_add_u32 m0, m0, 4096
    s_add_u32 s59, s59, 4096
    s_cmp_lt_u32 s59, 41472
    s_cbranch_scc1 L_mk8
    s_lshl_b32 s53, s52, 10
    s_add_u32 s53, s53, 2385920
    s_add_u32 s42, s53, s54
    s_add_u32 s43, s42, 4608
    s_add_u32 s53, s53, 36864
    s_lshl2_add_u32 s55, s2, s40
    s_bitcmp1_b32 0xcc, s55
    s_cselect_b32 s44, s53, 2.0
    s_mul_i32 s53, s40, 4608
    s_add_u32 s53, s53, s54
    s_add_u32 s53, s53, 2390016
    s_cmp_lt_u32 s40, 2
    s_cselect_b32 s45, s53, 2.0
    s_cmp_eq_u32 s55, 0
    s_cselect_b32 s46, 2426880, s46
    s_lshl_b32 s47, s55, 10
    s_add_u32 s47, s47, 2368000
    s_bfe_u32 s75, s4, 393227
    s_mul_i32 s75, s75, 2621440
    s_add_u32 s75, s75, 12582912
    s_mov_b32 s48, 0
    s_waitcnt vmcnt(0)
    s_barrier
L_mf0:
    s_nop 0
    ds_read_b128 v[16:19], v184 offset:0
    ds_read_b128 v[52:55], v160 offset:41984
    ds_read_b128 v[34:37], v186 offset:0
    ds_read_b128 v[70:73], v162 offset:41984
    ds_read_b128 v[106:109], v164 offset:51200
    ds_read_b128 v[20:23], v184 offset:64
    ds_read_b128 v[56:59], v160 offset:42048
    ds_read_b128 v[38:41], v186 offset:64
    ds_read_b128 v[74:77], v162 offset:42048
    ds_read_b128 v[110:113], v164 offset:51264
    ds_read_b128 v[24:27], v184 offset:128
    ds_read_b128 v[60:63], v160 offset:42112
    ds_read_b128 v[42:45], v186 offset:128
    ds_read_b128 v[78:81], v162 offset:42112
    ds_read_b128 v[114:117], v164 offset:51328
    ds_read_b128 v[28:31], v184 offset:192
    ds_read_b128 v[64:67], v160 offset:42176
    ds_read_b128 v[46:49], v186 offset:192
    ds_read_b128 v[82:85], v162 offset:42176
    ds_read_b128 v[118:121], v164 offset:51392
    ds_read_b64 v[32:33], v185 offset:256
    ds_read_b64 v[68:69], v161 offset:42240
    ds_read_b64 v[50:51], v187 offset:256
    ds_read_b64 v[86:87], v163 offset:42240
    ds_read_b64 v[122:123], v165 offset:51456
    buffer_load_dword v253, off, s[20:23], 0 sc1
    s_waitcnt lgkmcnt(15)
    s_nop 0
    v_mfma_f32_16x16x32_bf16 v[140:143], v[16:19], v[106:109], 0
    v_mfma_f32_16x16x32_bf16 v[144:147], v[34:37], v[106:109], 0
    v_mfma_f32_16x16x32_bf16 v[124:127], v[16:19], v[52:55], 0
    v_mfma_f32_16x16x32_bf16 v[128:131], v[34:37], v[52:55], 0
    v_mfma_f32_16x16x32_bf16 v[132:135], v[16:19], v[70:73], 0
    v_mfma_f32_16x16x32_bf16 v[136:139], v[34:37], v[70:73], 0
    s_waitcnt lgkmcnt(15)
    s_nop 0
    v_mfma_f32_16x16x32_bf16 v[140:143], v[20:23], v[110:113], v[140:143]
    v_mfma_f32_16x16x32_bf16 v[144:147], v[38:41], v[110:113], v[144:147]
    v_mfma_f32_16x16x32_bf16 v[124:127], v[20:23], v[56:59], v[124:127]
    v_mfma_f32_16x16x32_bf16 v[128:131], v[38:41], v[56:59], v[128:131]
    v_mfma_f32_16x16x32_bf16 v[132:135], v[20:23], v[74:77], v[132:135]
    v_mfma_f32_16x16x32_bf16 v[136:139], v[38:41], v[74:77], v[136:139]
    s_cbranch_execz L_mfd
    L_mfa:
    s_waitcnt lgkmcnt(10)
    v_mfma_f32_16x16x32_bf16 v[140:143], v[24:27], v[114:117], v[140:143]
    v_mfma_f32_16x16x32_bf16 v[144:147], v[42:45], v[114:117], v[144:147]
    v_mfma_f32_16x16x32_bf16 v[124:127], v[24:27], v[60:63], v[124:127]
    v_mfma_f32_16x16x32_bf16 v[128:131], v[42:45], v[60:63], v[128:131]
    v_mfma_f32_16x16x32_bf16 v[132:135], v[24:27], v[78:81], v[132:135]
    v_mfma_f32_16x16x32_bf16 v[136:139], v[42:45], v[78:81], v[136:139]
    s_cmp_ge_u32 s40, 2
    s_cbranch_scc1 L_mf1
    ds_read_b128 v[88:91], v164 offset:36864
    ds_read_b128 v[92:95], v164 offset:36928
    ds_read_b128 v[96:99], v164 offset:36992
    ds_read_b128 v[100:103], v164 offset:37056
    ds_read_b64 v[104:105], v165 offset:37120
    s_waitcnt lgkmcnt(10)
    s_nop 0
    v_mfma_f32_16x16x32_bf16 v[140:143], v[28:31], v[118:121], v[140:143]
    v_mfma_f32_16x16x32_bf16 v[144:147], v[46:49], v[118:121], v[144:147]
    v_mfma_f32_16x16x32_bf16 v[124:127], v[28:31], v[64:67], v[124:127]
    v_mfma_f32_16x16x32_bf16 v[128:131], v[46:49], v[64:67], v[128:131]
    v_mfma_f32_16x16x32_bf16 v[132:135], v[28:31], v[82:85], v[132:135]
    v_mfma_f32_16x16x32_bf16 v[136:139], v[46:49], v[82:85], v[136:139]
    s_waitcnt lgkmcnt(0)
    s_cmp_eq_u32 s40, 1
    s_cbranch_scc1 L_mf3
    s_nop 0
    v_mfma_f32_16x16x32_bf16 v[148:151], v[88:91], v[52:55], 0
    v_mfma_f32_16x16x32_bf16 v[152:155], v[88:91], v[106:109], 0
    v_mfma_f32_16x16x32_bf16 v[148:151], v[92:95], v[56:59], v[148:151]
    v_mfma_f32_16x16x32_bf16 v[152:155], v[92:95], v[110:113], v[152:155]
    v_mfma_f32_16x16x32_bf16 v[148:151], v[96:99], v[60:63], v[148:151]
    v_mfma_f32_16x16x32_bf16 v[152:155], v[96:99], v[114:117], v[152:155]
    v_mfma_f32_16x16x32_bf16 v[148:151], v[100:103], v[64:67], v[148:151]
    v_mfma_f32_16x16x32_bf16 v[152:155], v[100:103], v[118:121], v[152:155]
    v_mfma_f32_16x16x16_bf16 v[140:143], v[32:33], v[122:123], v[140:143]
    v_mfma_f32_16x16x16_bf16 v[144:147], v[50:51], v[122:123], v[144:147]
    v_mfma_f32_16x16x16_bf16 v[124:127], v[32:33], v[68:69], v[124:127]
    v_mfma_f32_16x16x16_bf16 v[128:131], v[50:51], v[68:69], v[128:131]
    v_mfma_f32_16x16x16_bf16 v[132:135], v[32:33], v[86:87], v[132:135]
    v_mfma_f32_16x16x16_bf16 v[136:139], v[50:51], v[86:87], v[136:139]
    v_mfma_f32_16x16x16_bf16 v[148:151], v[104:105], v[68:69], v[148:151]
    v_mfma_f32_16x16x16_bf16 v[152:155], v[104:105], v[122:123], v[152:155]
    s_cbranch_execz L_mst
    s_branch L_mf7
L_mf3:
    v_mfma_f32_16x16x32_bf16 v[148:151], v[88:91], v[70:73], 0
    v_mfma_f32_16x16x32_bf16 v[152:155], v[88:91], v[106:109], 0
    v_mfma_f32_16x16x32_bf16 v[148:151], v[92:95], v[74:77], v[148:151]
    v_mfma_f32_16x16x32_bf16 v[152:155], v[92:95], v[110:113], v[152:155]
    v_mfma_f32_16x16x32_bf16 v[148:151], v[96:99], v[78:81], v[148:151]
    v_mfma_f32_16x16x32_bf16 v[152:155], v[96:99], v[114:117], v[152:155]
    v_mfma_f32_16x16x32_bf16 v[148:151], v[100:103], v[82:85], v[148:151]
    v_mfma_f32_16x16x32_bf16 v[152:155], v[100:103], v[118:121], v[152:155]
    v_mfma_f32_16x16x16_bf16 v[140:143], v[32:33], v[122:123], v[140:143]
    v_mfma_f32_16x16x16_bf16 v[144:147], v[50:51], v[122:123], v[144:147]
    v_mfma_f32_16x16x16_bf16 v[124:127], v[32:33], v[68:69], v[124:127]
    v_mfma_f32_16x16x16_bf16 v[128:131], v[50:51], v[68:69], v[128:131]
    v_mfma_f32_16x16x16_bf16 v[132:135], v[32:33], v[86:87], v[132:135]
    v_mfma_f32_16x16x16_bf16 v[136:139], v[50:51], v[86:87], v[136:139]
    v_mfma_f32_16x16x16_bf16 v[148:151], v[104:105], v[86:87], v[148:151]
    v_mfma_f32_16x16x16_bf16 v[152:155], v[104:105], v[122:123], v[152:155]
    s_cbranch_execz L_mf1
    s_branch L_mf7
L_mf1:
    s_waitcnt lgkmcnt(5)
    s_nop 0
    v_mfma_f32_16x16x32_bf16 v[140:143], v[28:31], v[118:121], v[140:143]
    v_mfma_f32_16x16x32_bf16 v[144:147], v[46:49], v[118:121], v[144:147]
    v_mfma_f32_16x16x32_bf16 v[124:127], v[28:31], v[64:67], v[124:127]
    v_mfma_f32_16x16x32_bf16 v[128:131], v[46:49], v[64:67], v[128:131]
    v_mfma_f32_16x16x32_bf16 v[132:135], v[28:31], v[82:85], v[132:135]
    v_mfma_f32_16x16x32_bf16 v[136:139], v[46:49], v[82:85], v[136:139]
    s_waitcnt lgkmcnt(0)
    s_nop 0
    v_mfma_f32_16x16x16_bf16 v[140:143], v[32:33], v[122:123], v[140:143]
    v_mfma_f32_16x16x16_bf16 v[144:147], v[50:51], v[122:123], v[144:147]
    v_mfma_f32_16x16x16_bf16 v[124:127], v[32:33], v[68:69], v[124:127]
    v_mfma_f32_16x16x16_bf16 v[128:131], v[50:51], v[68:69], v[128:131]
    v_mfma_f32_16x16x16_bf16 v[132:135], v[32:33], v[86:87], v[132:135]
    v_mfma_f32_16x16x16_bf16 v[136:139], v[50:51], v[86:87], v[136:139]
L_mf7:
    s_nop 3
    s_nop 0
    v_subrev_f32_dpp v124, v140, v124 row_newbcast:0 row_mask:0xf bank_mask:0xf
    v_subrev_f32_dpp v125, v141, v125 row_newbcast:0 row_mask:0xf bank_mask:0xf
    v_subrev_f32_dpp v126, v142, v126 row_newbcast:0 row_mask:0xf bank_mask:0xf
    v_subrev_f32_dpp v127, v143, v127 row_newbcast:0 row_mask:0xf bank_mask:0xf
    v_pk_mul_f32 v[124:125], v[124:125], v[246:247] op_sel_hi:[1,0]
    v_pk_mul_f32 v[126:127], v[126:127], v[246:247] op_sel_hi:[1,0]
    v_cvt_pk_bf16_f32 v168, v124, v125
    v_cvt_pk_bf16_f32 v169, v126, v127
    v_subrev_f32_dpp v128, v144, v128 row_newbcast:0 row_mask:0xf bank_mask:0xf
    v_subrev_f32_dpp v129, v145, v129 row_newbcast:0 row_mask:0xf bank_mask:0xf
    v_subrev_f32_dpp v130, v146, v130 row_newbcast:0 row_mask:0xf bank_mask:0xf
    v_subrev_f32_dpp v131, v147, v131 row_newbcast:0 row_mask:0xf bank_mask:0xf
    v_pk_mul_f32 v[128:129], v[128:129], v[246:247] op_sel_hi:[1,0]
    v_pk_mul_f32 v[130:131], v[130:131], v[246:247] op_sel_hi:[1,0]
    v_cvt_pk_bf16_f32 v170, v128, v129
    v_cvt_pk_bf16_f32 v171, v130, v131
    v_subrev_f32_dpp v132, v140, v132 row_newbcast:0 row_mask:0xf bank_mask:0xf
    v_subrev_f32_dpp v133, v141, v133 row_newbcast:0 row_mask:0xf bank_mask:0xf
    v_subrev_f32_dpp v134, v142, v134 row_newbcast:0 row_mask:0xf bank_mask:0xf
    v_subrev_f32_dpp v135, v143, v135 row_newbcast:0 row_mask:0xf bank_mask:0xf
    v_pk_mul_f32 v[132:133], v[132:133], v[246:247] op_sel_hi:[1,0]
    v_pk_mul_f32 v[134:135], v[134:135], v[246:247] op_sel_hi:[1,0]
    v_cvt_pk_bf16_f32 v172, v132, v133
    v_cvt_pk_bf16_f32 v173, v134, v135
    s_cbranch_execz L_mf9
    L_mfc:
    s_nop 0
    v_subrev_f32_dpp v136, v144, v136 row_newbcast:0 row_mask:0xf bank_mask:0xf
    v_subrev_f32_dpp v137, v145, v137 row_newbcast:0 row_mask:0xf bank_mask:0xf
    v_subrev_f32_dpp v138, v146, v138 row_newbcast:0 row_mask:0xf bank_mask:0xf
    v_subrev_f32_dpp v139, v147, v139 row_newbcast:0 row_mask:0xf bank_mask:0xf
    v_pk_mul_f32 v[136:137], v[136:137], v[246:247] op_sel_hi:[1,0]
    v_pk_mul_f32 v[138:139], v[138:139], v[246:247] op_sel_hi:[1,0]
    v_cvt_pk_bf16_f32 v174, v136, v137
    v_cvt_pk_bf16_f32 v175, v138, v139
    s_cbranch_execz L_mfe
    s_waitcnt vmcnt(0)
    v_readfirstlane_b32 s98, v253
    s_bfe_u32 s56, s98, 393227
    s_mul_i32 s56, s56, 2621440
    s_add_u32 s56, s56, 12582912
    s_cmp_lg_u32 s98, 0
    s_cselect_b32 s75, s56, s75
    s_add_u32 s8, s12, s75
    s_addc_u32 s9, s13, 0
L_mfe:
    s_nop 0
    buffer_store_dwordx4 v[168:171], v6, s[8:11], s42 offen sc1
    buffer_store_dwordx4 v[172:175], v6, s[8:11], s43 offen sc1
    v_subrev_f32_dpp v148, v152, v148 row_newbcast:0 row_mask:0xf bank_mask:0xf
    v_subrev_f32_dpp v149, v153, v149 row_newbcast:0 row_mask:0xf bank_mask:0xf
    v_subrev_f32_dpp v150, v154, v150 row_newbcast:0 row_mask:0xf bank_mask:0xf
    v_subrev_f32_dpp v151, v155, v151 row_newbcast:0 row_mask:0xf bank_mask:0xf
    v_pk_mul_f32 v[148:149], v[148:149], v[246:247] op_sel_hi:[1,0]
    v_pk_mul_f32 v[150:151], v[150:151], v[246:247] op_sel_hi:[1,0]
    v_cvt_pk_bf16_f32 v180, v148, v149
    v_cvt_pk_bf16_f32 v181, v150, v151
    buffer_store_dwordx2 v[180:181], v166, s[8:11], s45 offen sc1
    s_cbranch_execz L_mf9
    L_mfd:
    s_nop 0
    v_subrev_f32_dpp v140, v140, v140 row_newbcast:0 row_mask:0xf bank_mask:0xf
    v_subrev_f32_dpp v141, v141, v141 row_newbcast:0 row_mask:0xf bank_mask:0xf
    v_subrev_f32_dpp v142, v142, v142 row_newbcast:0 row_mask:0xf bank_mask:0xf
    v_subrev_f32_dpp v143, v143, v143 row_newbcast:0 row_mask:0xf bank_mask:0xf
    v_pk_mul_f32 v[140:141], v[140:141], v[246:247] op_sel_hi:[1,0]
    v_pk_mul_f32 v[142:143], v[142:143], v[246:247] op_sel_hi:[1,0]
    v_cvt_pk_bf16_f32 v176, v140, v141
    v_cvt_pk_bf16_f32 v177, v142, v143
    v_subrev_f32_dpp v144, v144, v144 row_newbcast:0 row_mask:0xf bank_mask:0xf
    v_subrev_f32_dpp v145, v145, v145 row_newbcast:0 row_mask:0xf bank_mask:0xf
    v_subrev_f32_dpp v146, v146, v146 row_newbcast:0 row_mask:0xf bank_mask:0xf
    v_subrev_f32_dpp v147, v147, v147 row_newbcast:0 row_mask:0xf bank_mask:0xf
    v_pk_mul_f32 v[144:145], v[144:145], v[246:247] op_sel_hi:[1,0]
    v_pk_mul_f32 v[146:147], v[146:147], v[246:247] op_sel_hi:[1,0]
    v_cvt_pk_bf16_f32 v178, v144, v145
    v_cvt_pk_bf16_f32 v179, v146, v147
    buffer_store_dwordx4 v[176:179], v6, s[8:11], s44 offen sc1
    s_cbranch_execz L_mf9
    L_mst:
    s_nop 0
    v_subrev_f32_dpp v152, v152, v152 row_newbcast:0 row_mask:0xf bank_mask:0xf
    v_subrev_f32_dpp v153, v153, v153 row_newbcast:0 row_mask:0xf bank_mask:0xf
    v_subrev_f32_dpp v154, v154, v154 row_newbcast:0 row_mask:0xf bank_mask:0xf
    v_subrev_f32_dpp v155, v155, v155 row_newbcast:0 row_mask:0xf bank_mask:0xf
    v_pk_mul_f32 v[152:153], v[152:153], v[246:247] op_sel_hi:[1,0]
    v_pk_mul_f32 v[154:155], v[154:155], v[246:247] op_sel_hi:[1,0]
    v_cvt_pk_bf16_f32 v182, v152, v153
    v_cvt_pk_bf16_f32 v183, v154, v155
    buffer_store_dwordx2 v[182:183], v166, s[8:11], s46 offen sc1
    s_mov_b32 s53, s48
    s_or_b32 s56, s98, s48
    s_cbranch_scc1 L_mfl
L_mtag:
    buffer_load_dword v253, off, s[20:23], 0 sc1
    s_add_u32 s53, s53, 1
    s_waitcnt vmcnt(0)
    v_readfirstlane_b32 s98, v253
    s_cmp_lt_u32 s53, 0x40000
    s_cselect_b32 s56, s98, 1
    s_cmp_eq_u32 s56, 0
    s_cbranch_scc1 L_mtag
    s_bfe_u32 s56, s98, 393227
    s_mul_i32 s56, s56, 2621440
    s_add_u32 s56, s56, 12582912
    s_cmp_eq_u32 s56, s75
    s_cbranch_scc1 L_mfl
    s_mov_b32 s75, s56
    s_add_u32 s8, s12, s75
    s_addc_u32 s9, s13, 0
    buffer_store_dwordx4 v[168:171], v6, s[8:11], s42 offen sc1
    buffer_store_dwordx4 v[172:175], v6, s[8:11], s43 offen sc1
    buffer_store_dwordx4 v[176:179], v6, s[8:11], s44 offen sc1
    buffer_store_dwordx2 v[180:181], v166, s[8:11], s45 offen sc1
    buffer_store_dwordx2 v[182:183], v166, s[8:11], s46 offen sc1
L_mfl:
    v_mov_b32 v16, s98
    v_mov_b32 v17, s98
    v_mov_b32 v18, s98
    v_mov_b32 v19, s98
    s_cbranch_execz L_mf9
    s_waitcnt vmcnt(0)
    buffer_store_dwordx4 v[16:19], v6, s[8:11], s47 offen sc1
    s_barrier
L_mf6:
    s_cmp_ge_u32 s2, 2
    s_cbranch_scc1 L_end
    s_mov_b32 s20, s76
    s_mov_b32 s21, s77
    s_mov_b32 s22, 256
    s_mov_b32 s23, 0x20000
    s_mov_b32 s8, s72
    s_mov_b32 s9, s73
    s_mov_b32 s10, 82944
    s_mov_b32 s11, 0x20000
    s_mov_b32 s28, s62
    s_mov_b32 s29, s63
    s_mov_b32 s30, 41472
    s_mov_b32 s31, 0x20000
    s_cmp_eq_u32 s2, 0
    s_cselect_b32 s24, s64, s70
    s_cselect_b32 s25, s65, s71
    s_mov_b32 s26, 41472
    s_mov_b32 s27, 0x20000
    s_cselect_b32 s56, 0, 41472
    s_lshl_b32 s52, s40, 6
    v_add_u32 v213, s52, v0
    v_mul_u32_u24 v212, 3450, v213
    v_lshrrev_b32 v212, 16, v212
    v_mul_u32_u24 v214, 19, v212
    v_sub_u32_e64 v213, v213, v214
    v_mul_u32_u24 v212, 288, v212
    v_lshl_add_u32 v212, v213, 4, v212
    s_lshl_b32 s52, s40, 10
    v_mov_b32 v214, -16
    s_add_u32 m0, s52, 0
    s_nop 0
    buffer_load_dwordx4 v212, s[24:27], 0 offen lds
    s_add_u32 m0, s52, 44032
    s_nop 0
    buffer_load_dwordx4 v212, s[28:31], 0 offen lds
    v_add_u32_e64 v213, 9, v213
    v_cmp_le_u32 vcc, 19, v213
    v_add_u32 v212, 3888, v212
    v_subrev_u32 v215, 19, v213
    v_cndmask_b32 v213, v213, v215, vcc
    v_cndmask_b32 v215, 0, v214, vcc
    v_add_u32 v212, v212, v215
    s_add_u32 m0, s52, 4096
    s_nop 0
    buffer_load_dwordx4 v212, s[24:27], 0 offen lds
    s_add_u32 m0, s52, 48128
    s_nop 0
    buffer_load_dwordx4 v212, s[28:31], 0 offen lds
    v_add_u32 v213, 9, v213
    v_cmp_le_u32 vcc, 19, v213
    v_add_u32 v212, 3888, v212
    v_subrev_u32 v215, 19, v213
    v_cndmask_b32 v213, v213, v215, vcc
    v_cndmask_b32 v215, 0, v214, vcc
    v_add_u32 v212, v212, v215
    s_add_u32 m0, s52, 8192
    s_nop 0
    buffer_load_dwordx4 v212, s[24:27], 0 offen lds
    s_add_u32 m0, s52, 52224
    s_nop 0
    buffer_load_dwordx4 v212, s[28:31], 0 offen lds
    v_add_u32 v213, 9, v213
    v_cmp_le_u32 vcc, 19, v213
    v_add_u32 v212, 3888, v212
    v_subrev_u32 v215, 19, v213
    v_cndmask_b32 v213, v213, v215, vcc
    v_cndmask_b32 v215, 0, v214, vcc
    v_add_u32 v212, v212, v215
    s_add_u32 m0, s52, 12288
    s_nop 0
    buffer_load_dwordx4 v212, s[24:27], 0 offen lds
    s_add_u32 m0, s52, 56320
    s_nop 0
    buffer_load_dwordx4 v212, s[28:31], 0 offen lds
    v_add_u32 v213, 9, v213
    v_cmp_le_u32 vcc, 19, v213
    v_add_u32 v212, 3888, v212
    v_subrev_u32 v215, 19, v213
    v_cndmask_b32 v213, v213, v215, vcc
    v_cndmask_b32 v215, 0, v214, vcc
    v_add_u32 v212, v212, v215
    s_add_u32 m0, s52, 16384
    s_nop 0
    buffer_load_dwordx4 v212, s[24:27], 0 offen lds
    s_add_u32 m0, s52, 60416
    s_nop 0
    buffer_load_dwordx4 v212, s[28:31], 0 offen lds
    v_add_u32 v213, 9, v213
    v_cmp_le_u32 vcc, 19, v213
    v_add_u32 v212, 3888, v212
    v_subrev_u32 v215, 19, v213
    v_cndmask_b32 v213, v213, v215, vcc
    v_cndmask_b32 v215, 0, v214, vcc
    v_add_u32 v212, v212, v215
    s_add_u32 m0, s52, 20480
    s_nop 0
    buffer_load_dwordx4 v212, s[24:27], 0 offen lds
    s_add_u32 m0, s52, 64512
    s_nop 0
    buffer_load_dwordx4 v212, s[28:31], 0 offen lds
    v_add_u32 v213, 9, v213
    v_cmp_le_u32 vcc, 19, v213
    v_add_u32 v212, 3888, v212
    v_subrev_u32 v215, 19, v213
    v_cndmask_b32 v213, v213, v215, vcc
    v_cndmask_b32 v215, 0, v214, vcc
    v_add_u32 v212, v212, v215
    s_add_u32 m0, s52, 24576
    s_nop 0
    buffer_load_dwordx4 v212, s[24:27], 0 offen lds
    s_add_u32 m0, s52, 68608
    s_nop 0
    buffer_load_dwordx4 v212, s[28:31], 0 offen lds
    v_add_u32 v213, 9, v213
    v_cmp_le_u32 vcc, 19, v213
    v_add_u32 v212, 3888, v212
    v_subrev_u32 v215, 19, v213
    v_cndmask_b32 v213, v213, v215, vcc
    v_cndmask_b32 v215, 0, v214, vcc
    v_add_u32 v212, v212, v215
    s_add_u32 m0, s52, 28672
    s_nop 0
    buffer_load_dwordx4 v212, s[24:27], 0 offen lds
    s_add_u32 m0, s52, 72704
    s_nop 0
    buffer_load_dwordx4 v212, s[28:31], 0 offen lds
    v_add_u32 v213, 9, v213
    v_cmp_le_u32 vcc, 19, v213
    v_add_u32 v212, 3888, v212
    v_subrev_u32 v215, 19, v213
    v_cndmask_b32 v213, v213, v215, vcc
    v_cndmask_b32 v215, 0, v214, vcc
    v_add_u32 v212, v212, v215
    s_add_u32 m0, s52, 32768
    s_nop 0
    buffer_load_dwordx4 v212, s[24:27], 0 offen lds
    s_add_u32 m0, s52, 76800
    s_nop 0
    buffer_load_dwordx4 v212, s[28:31], 0 offen lds
    v_add_u32 v213, 9, v213
    v_cmp_le_u32 vcc, 19, v213
    v_add_u32 v212, 3888, v212
    v_subrev_u32 v215, 19, v213
    v_cndmask_b32 v213, v213, v215, vcc
    v_cndmask_b32 v215, 0, v214, vcc
    v_add_u32 v212, v212, v215
    s_add_u32 m0, s52, 36864
    s_nop 0
    buffer_load_dwordx4 v212, s[24:27], 0 offen lds
    s_add_u32 m0, s52, 80896
    s_nop 0
    buffer_load_dwordx4 v212, s[28:31], 0 offen lds
    v_add_u32 v213, 9, v213
    v_cmp_le_u32 vcc, 19, v213
    v_add_u32 v212, 3888, v212
    v_subrev_u32 v215, 19, v213
    v_cndmask_b32 v213, v213, v215, vcc
    v_cndmask_b32 v215, 0, v214, vcc
    v_add_u32 v212, v212, v215
    s_cmp_ge_u32 s40, 3
    s_cbranch_scc1 L_wf1
    s_add_u32 m0, s52, 40960
    s_nop 0
    buffer_load_dwordx4 v212, s[24:27], 0 offen lds
    s_add_u32 m0, s52, 84992
    s_nop 0
    buffer_load_dwordx4 v212, s[28:31], 0 offen lds
L_wf1:
    s_lshl_b32 s52, s40, 10
    s_add_u32 s54, s52, s56
    s_add_u32 m0, s52, 88064
    s_add_u32 s53, s54, 0
    s_nop 0
    buffer_load_dwordx4 v6, s[8:11], s53 offen lds
    s_add_u32 m0, s52, 92160
    s_add_u32 s53, s54, 4096
    buffer_load_dwordx4 v6, s[8:11], s53 offen lds
    s_add_u32 m0, s52, 96256
    s_add_u32 s53, s54, 8192
    buffer_load_dwordx4 v6, s[8:11], s53 offen lds
    s_add_u32 m0, s52, 100352
    s_add_u32 s53, s54, 12288
    buffer_load_dwordx4 v6, s[8:11], s53 offen lds
    s_add_u32 m0, s52, 104448
    s_add_u32 s53, s54, 16384
    buffer_load_dwordx4 v6, s[8:11], s53 offen lds
    s_add_u32 m0, s52, 108544
    s_add_u32 s53, s54, 20480
    buffer_load_dwordx4 v6, s[8:11], s53 offen lds
    s_add_u32 m0, s52, 112640
    s_add_u32 s53, s54, 24576
    buffer_load_dwordx4 v6, s[8:11], s53 offen lds
    s_add_u32 m0, s52, 116736
    s_add_u32 s53, s54, 28672
    buffer_load_dwordx4 v6, s[8:11], s53 offen lds
    s_add_u32 m0, s52, 120832
    s_add_u32 s53, s54, 32768
    buffer_load_dwordx4 v6, s[8:11], s53 offen lds
    s_add_u32 m0, s52, 124928
    s_add_u32 s53, s54, 36864
    buffer_load_dwordx4 v6, s[8:11], s53 offen lds
    s_cmp_ge_u32 s40, 1
    s_cbranch_scc1 L_wf2
    s_add_u32 m0, s52, 129024
    s_add_u32 s53, s54, 40960
    buffer_load_dwordx4 v6, s[8:11], s53 offen lds
L_wf2:
    s_mov_b32 s36, s68
    s_mov_b32 s37, s69
    s_mov_b32 s38, 864
    s_mov_b32 s39, 0x20000
    v_and_b32 v208, 15, v0
    v_lshlrev_b32 v210, 4, v208
    v_lshlrev_b32_e64 v208, 1, v208
    v_bfe_u32 v211, v0, 4, 1
    v_lshl_add_u32 v209, v211, 7, v208
    v_lshl_add_u32 v210, v211, 11, v210
    v_and_b32 v211, 1, v0
    v_lshlrev_b32 v211, 4, v211
    v_bfe_i32 v212, v0, 1, 1
    v_not_b32 v213, v212
    s_nop 0
    buffer_load_ushort v16, v209, s[36:39], 0 offen offset:0
    buffer_load_ushort v18, v209, s[36:39], 0 offen offset:32
    buffer_load_ushort v20, v209, s[36:39], 0 offen offset:64
    buffer_load_ushort v22, v209, s[36:39], 0 offen offset:96
    buffer_load_ushort v24, v208, s[36:39], 0 offen offset:256
    buffer_load_ushort v17, v209, s[36:39], 0 offen offset:288
    buffer_load_ushort v19, v209, s[36:39], 0 offen offset:320
    buffer_load_ushort v21, v209, s[36:39], 0 offen offset:352
    buffer_load_ushort v23, v209, s[36:39], 0 offen offset:384
    buffer_load_ushort v25, v208, s[36:39], 0 offen offset:544
    buffer_load_ushort v26, v209, s[36:39], 0 offen offset:576
    buffer_load_ushort v27, v209, s[36:39], 0 offen offset:608
    buffer_load_ushort v28, v209, s[36:39], 0 offen offset:640
    buffer_load_ushort v29, v209, s[36:39], 0 offen offset:672
    buffer_load_ushort v30, v208, s[36:39], 0 offen offset:832
    s_mov_b32 s53, 9616384
    s_waitcnt vmcnt(0)
    v_lshlrev_b32 v16, v211, v16
    v_and_b32 v32, v213, v16
    v_and_b32 v33, v212, v16
    v_lshlrev_b32 v17, v211, v17
    v_and_b32 v34, v213, v17
    v_and_b32 v35, v212, v17
    v_lshlrev_b32 v18, v211, v18
    v_and_b32 v36, v213, v18
    v_and_b32 v37, v212, v18
    v_lshlrev_b32 v19, v211, v19
    v_and_b32 v38, v213, v19
    v_and_b32 v39, v212, v19
    v_lshlrev_b32 v20, v211, v20
    v_and_b32 v40, v213, v20
    v_and_b32 v41, v212, v20
    v_lshlrev_b32 v21, v211, v21
    v_and_b32 v42, v213, v21
    v_and_b32 v43, v212, v21
    v_lshlrev_b32 v22, v211, v22
    v_and_b32 v44, v213, v22
    v_and_b32 v45, v212, v22
    v_lshlrev_b32 v23, v211, v23
    v_and_b32 v46, v213, v23
    v_and_b32 v47, v212, v23
    v_lshlrev_b32 v24, v211, v24
    v_and_b32 v48, v213, v24
    v_and_b32 v49, v212, v24
    v_lshlrev_b32 v25, v211, v25
    v_and_b32 v50, v213, v25
    v_and_b32 v51, v212, v25
    v_lshlrev_b32 v26, v211, v26
    v_and_b32 v52, v213, v26
    v_and_b32 v53, v212, v26
    v_lshlrev_b32 v27, v211, v27
    v_and_b32 v54, v213, v27
    v_and_b32 v55, v212, v27
    v_lshlrev_b32 v28, v211, v28
    v_and_b32 v56, v213, v28
    v_and_b32 v57, v212, v28
    v_lshlrev_b32 v29, v211, v29
    v_and_b32 v58, v213, v29
    v_and_b32 v59, v212, v29
    v_lshlrev_b32 v30, v211, v30
    v_and_b32 v60, v213, v30
    v_and_b32 v61, v212, v30
    buffer_store_dwordx4 v[32:35], v210, s[12:15], s53 offen offset:0 sc1
    buffer_store_dwordx4 v[36:39], v210, s[12:15], s53 offen offset:256 sc1
    buffer_store_dwordx4 v[40:43], v210, s[12:15], s53 offen offset:512 sc1
    buffer_store_dwordx4 v[44:47], v210, s[12:15], s53 offen offset:768 sc1
    buffer_store_dwordx4 v[48:51], v210, s[12:15], s53 offen offset:1024 sc1
    buffer_store_dwordx4 v[52:55], v210, s[12:15], s53 offen offset:1280 sc1
    buffer_store_dwordx4 v[56:59], v210, s[12:15], s53 offen offset:1536 sc1
    buffer_store_dwordx2 v[60:61], v210, s[12:15], s53 offen offset:1792 sc1
    v_lshrrev_b32_e64 v216, 2, v0
    v_mul_u32_u24 v216, 288, v216
    v_and_b32_e64 v217, 3, v0
    v_lshl_add_u32 v216, v217, 3, v216
    v_add_u32 v242, 88064, v216
    v_mov_b32_e64 v240, v242
    v_add_u32 v241, 4608, v242
    v_and_b32_e64 v216, 15, v0
    v_mul_u32_u24 v216, 304, v216
    v_lshrrev_b32_e64 v217, 4, v0
    v_lshl_add_u32 v216, v217, 3, v216
    v_add_u32_e64 v243, 0, v216
    v_add_u32 v245, 44032, v243
    v_lshlrev_b32 v244, 3, v0
    s_lshr_b32 s52, s40, 1
    s_lshl_b32 s52, s52, 6
    s_and_b32 s53, s40, 1
    s_lshl_b32 s53, s53, 3
    s_add_u32 s52, s52, s53
    v_and_b32 v246, 3, v0
    v_lshlrev_b32 v246, 3, v246
    v_add_u32 v247, s52, v246
    v_add_u32 v240, v247, v240
    v_add_u32 v241, v247, v241
    v_add_u32_e64 v242, v247, v242
    s_mov_b32 s45, s40
    s_waitcnt vmcnt(0)
    s_barrier
L_wfl:
    ds_read_b64_tr_b16 v[88:89], v240 offset:0
    ds_read_b64_tr_b16 v[90:91], v241 offset:0
    ds_read_b64_tr_b16 v[92:93], v240 offset:9216
    ds_read_b64_tr_b16 v[94:95], v241 offset:9216
    ds_read_b64_tr_b16 v[96:97], v240 offset:18432
    ds_read_b64_tr_b16 v[98:99], v241 offset:18432
    ds_read_b64_tr_b16 v[100:101], v240 offset:27648
    ds_read_b64_tr_b16 v[102:103], v241 offset:27648
    ds_read_b64_tr_b16 v[104:105], v242 offset:36864
    s_waitcnt lgkmcnt(0)
    s_nop 0
    ds_read_b64 a[0:1], v243 offset:0
    ds_read_b64 a[2:3], v243 offset:32
    ds_read_b64 a[18:19], v243 offset:4864
    ds_read_b64 a[20:21], v243 offset:4896
    ds_read_b64 a[36:37], v243 offset:9728
    ds_read_b64 a[38:39], v243 offset:9760
    ds_read_b64 a[4:5], v243 offset:64
    ds_read_b64 a[6:7], v243 offset:96
    ds_read_b64 a[22:23], v243 offset:4928
    ds_read_b64 a[24:25], v243 offset:4960
    ds_read_b64 a[40:41], v243 offset:9792
    ds_read_b64 a[42:43], v243 offset:9824
    s_waitcnt lgkmcnt(6)
    s_nop 0
    v_mfma_f32_16x16x32_bf16 v[108:111], a[0:3], v[88:91], 0
    ds_read_b64 a[8:9], v243 offset:128
    ds_read_b64 a[10:11], v243 offset:160
    v_mfma_f32_16x16x32_bf16 v[112:115], a[18:21], v[88:91], 0
    ds_read_b64 a[26:27], v243 offset:4992
    ds_read_b64 a[28:29], v243 offset:5024
    v_mfma_f32_16x16x32_bf16 v[116:119], a[36:39], v[88:91], 0
    ds_read_b64 a[44:45], v243 offset:9856
    ds_read_b64 a[46:47], v243 offset:9888
    s_waitcnt lgkmcnt(6)
    s_nop 0
    v_mfma_f32_16x16x32_bf16 v[108:111], a[4:7], v[92:95], v[108:111]
    ds_read_b64 a[12:13], v243 offset:192
    ds_read_b64 a[14:15], v243 offset:224
    v_mfma_f32_16x16x32_bf16 v[112:115], a[22:25], v[92:95], v[112:115]
    ds_read_b64 a[30:31], v243 offset:5056
    ds_read_b64 a[32:33], v243 offset:5088
    v_mfma_f32_16x16x32_bf16 v[116:119], a[40:43], v[92:95], v[116:119]
    ds_read_b64 a[48:49], v243 offset:9920
    ds_read_b64 a[50:51], v243 offset:9952
    s_waitcnt lgkmcnt(6)
    s_nop 0
    v_mfma_f32_16x16x32_bf16 v[108:111], a[8:11], v[96:99], v[108:111]
    ds_read_b64 a[16:17], v243 offset:256
    ds_read_b64 a[34:35], v243 offset:5120
    v_mfma_f32_16x16x32_bf16 v[112:115], a[26:29], v[96:99], v[112:115]
    ds_read_b64 a[52:53], v243 offset:9984
    ds_read_b64 a[54:55], v243 offset:14592
    v_mfma_f32_16x16x32_bf16 v[116:119], a[44:47], v[96:99], v[116:119]
    ds_read_b64 a[56:57], v243 offset:14624
    ds_read_b64 a[72:73], v243 offset:19456
    s_waitcnt lgkmcnt(6)
    s_nop 0
    v_mfma_f32_16x16x32_bf16 v[108:111], a[12:15], v[100:103], v[108:111]
    ds_read_b64 a[74:75], v243 offset:19488
    ds_read_b64 a[90:91], v243 offset:24320
    v_mfma_f32_16x16x32_bf16 v[112:115], a[30:33], v[100:103], v[112:115]
    ds_read_b64 a[92:93], v243 offset:24352
    ds_read_b64 a[58:59], v243 offset:14656
    v_mfma_f32_16x16x32_bf16 v[116:119], a[48:51], v[100:103], v[116:119]
    ds_read_b64 a[60:61], v243 offset:14688
    ds_read_b64 a[76:77], v243 offset:19520
    s_waitcnt lgkmcnt(3)
    s_nop 0
    v_mfma_f32_16x16x32_bf16 v[120:123], a[54:57], v[88:91], 0
    ds_read_b64 a[78:79], v243 offset:19552
    ds_read_b64 a[94:95], v243 offset:24384
    v_mfma_f32_16x16x32_bf16 v[124:127], a[72:75], v[88:91], 0
    ds_read_b64 a[96:97], v243 offset:24416
    ds_read_b64 a[62:63], v243 offset:14720
    v_mfma_f32_16x16x32_bf16 v[128:131], a[90:93], v[88:91], 0
    ds_read_b64 a[64:65], v243 offset:14752
    ds_read_b64 a[80:81], v243 offset:19584
    v_mfma_f32_16x16x16_bf16 v[108:111], a[16:17], v[104:105], v[108:111]
    ds_read_b64 a[82:83], v243 offset:19616
    ds_read_b64 a[98:99], v243 offset:24448
    v_mfma_f32_16x16x16_bf16 v[112:115], a[34:35], v[104:105], v[112:115]
    ds_read_b64 a[100:101], v243 offset:24480
    ds_read_b64 a[66:67], v243 offset:14784
    v_mfma_f32_16x16x16_bf16 v[116:119], a[52:53], v[104:105], v[116:119]
    ds_read_b64 a[68:69], v243 offset:14816
    ds_read_b64 a[84:85], v243 offset:19648
    s_waitcnt lgkmcnt(9)
    s_nop 0
    v_mfma_f32_16x16x32_bf16 v[120:123], a[58:61], v[92:95], v[120:123]
    ds_read_b64 a[86:87], v243 offset:19680
    ds_read_b64 a[102:103], v243 offset:24512
    v_mfma_f32_16x16x32_bf16 v[124:127], a[76:79], v[92:95], v[124:127]
    ds_read_b64 a[104:105], v243 offset:24544
    ds_read_b64 a[70:71], v243 offset:14848
    v_mfma_f32_16x16x32_bf16 v[128:131], a[94:97], v[92:95], v[128:131]
    ds_read_b64 a[88:89], v243 offset:19712
    ds_read_b64 a[106:107], v243 offset:24576
    s_waitcnt lgkmcnt(9)
    s_nop 0
    v_mfma_f32_16x16x32_bf16 v[120:123], a[62:65], v[96:99], v[120:123]
    ds_read_b64 a[0:1], v243 offset:29184
    ds_read_b64 a[2:3], v243 offset:29216
    v_mfma_f32_16x16x32_bf16 v[124:127], a[80:83], v[96:99], v[124:127]
    ds_read_b64 a[18:19], v243 offset:34048
    ds_read_b64 a[20:21], v243 offset:34080
    v_mfma_f32_16x16x32_bf16 v[128:131], a[98:101], v[96:99], v[128:131]
    ds_read_b64 a[36:37], v243 offset:38912
    ds_read_b64 a[38:39], v243 offset:38944
    s_waitcnt lgkmcnt(9)
    s_nop 0
    v_mfma_f32_16x16x32_bf16 v[120:123], a[66:69], v[100:103], v[120:123]
    ds_read_b64 a[4:5], v243 offset:29248
    ds_read_b64 a[6:7], v243 offset:29280
    v_mfma_f32_16x16x32_bf16 v[124:127], a[84:87], v[100:103], v[124:127]
    ds_read_b64 a[22:23], v243 offset:34112
    ds_read_b64 a[24:25], v243 offset:34144
    v_mfma_f32_16x16x32_bf16 v[128:131], a[102:105], v[100:103], v[128:131]
    ds_read_b64 a[40:41], v243 offset:38976
    ds_read_b64 a[42:43], v243 offset:39008
    s_waitcnt lgkmcnt(6)
    s_nop 0
    v_mfma_f32_16x16x32_bf16 v[132:135], a[0:3], v[88:91], 0
    ds_read_b64 a[8:9], v243 offset:29312
    ds_read_b64 a[10:11], v243 offset:29344
    v_mfma_f32_16x16x32_bf16 v[136:139], a[18:21], v[88:91], 0
    ds_read_b64 a[26:27], v243 offset:34176
    ds_read_b64 a[28:29], v243 offset:34208
    v_mfma_f32_16x16x32_bf16 v[140:143], a[36:39], v[88:91], 0
    ds_read_b64 a[44:45], v243 offset:39040
    ds_read_b64 a[46:47], v243 offset:39072
    v_mfma_f32_16x16x16_bf16 v[120:123], a[70:71], v[104:105], v[120:123]
    ds_read_b64 a[12:13], v243 offset:29376
    ds_read_b64 a[14:15], v243 offset:29408
    v_mfma_f32_16x16x16_bf16 v[124:127], a[88:89], v[104:105], v[124:127]
    ds_read_b64 a[30:31], v243 offset:34240
    ds_read_b64 a[32:33], v243 offset:34272
    v_mfma_f32_16x16x16_bf16 v[128:131], a[106:107], v[104:105], v[128:131]
    ds_read_b64 a[48:49], v243 offset:39104
    ds_read_b64 a[50:51], v243 offset:39136
    s_waitcnt lgkmcnt(12)
    s_nop 0
    v_mfma_f32_16x16x32_bf16 v[132:135], a[4:7], v[92:95], v[132:135]
    ds_read_b64 a[16:17], v243 offset:29440
    ds_read_b64 a[34:35], v243 offset:34304
    v_mfma_f32_16x16x32_bf16 v[136:139], a[22:25], v[92:95], v[136:139]
    ds_read_b64 a[52:53], v243 offset:39168
    v_mfma_f32_16x16x32_bf16 v[140:143], a[40:43], v[92:95], v[140:143]
    s_waitcnt lgkmcnt(9)
    v_mfma_f32_16x16x32_bf16 v[132:135], a[8:11], v[96:99], v[132:135]
    v_mfma_f32_16x16x32_bf16 v[136:139], a[26:29], v[96:99], v[136:139]
    v_mfma_f32_16x16x32_bf16 v[140:143], a[44:47], v[96:99], v[140:143]
    s_waitcnt lgkmcnt(3)
    v_mfma_f32_16x16x32_bf16 v[132:135], a[12:15], v[100:103], v[132:135]
    v_mfma_f32_16x16x32_bf16 v[136:139], a[30:33], v[100:103], v[136:139]
    v_mfma_f32_16x16x32_bf16 v[140:143], a[48:51], v[100:103], v[140:143]
    s_waitcnt lgkmcnt(0)
    s_nop 2
    v_mfma_f32_16x16x16_bf16 v[132:135], a[16:17], v[104:105], v[132:135]
    v_mfma_f32_16x16x16_bf16 v[136:139], a[34:35], v[104:105], v[136:139]
    v_mfma_f32_16x16x16_bf16 v[140:143], a[52:53], v[104:105], v[140:143]
    s_nop 7
    s_nop 0
    v_cvt_pk_bf16_f32 v88, v108, v109
    v_cvt_pk_bf16_f32 v89, v110, v111
    v_cvt_pk_bf16_f32 v90, v112, v113
    v_cvt_pk_bf16_f32 v91, v114, v115
    v_cvt_pk_bf16_f32 v92, v116, v117
    v_cvt_pk_bf16_f32 v93, v118, v119
    v_cvt_pk_bf16_f32 v94, v120, v121
    v_cvt_pk_bf16_f32 v95, v122, v123
    v_cvt_pk_bf16_f32 v96, v124, v125
    v_cvt_pk_bf16_f32 v97, v126, v127
    v_cvt_pk_bf16_f32 v98, v128, v129
    v_cvt_pk_bf16_f32 v99, v130, v131
    v_cvt_pk_bf16_f32 v100, v132, v133
    v_cvt_pk_bf16_f32 v101, v134, v135
    v_cvt_pk_bf16_f32 v102, v136, v137
    v_cvt_pk_bf16_f32 v103, v138, v139
    v_cvt_pk_bf16_f32 v104, v140, v141
    v_cvt_pk_bf16_f32 v105, v142, v143
    s_cmp_eq_u32 s2, 0
    s_cbranch_scc0 L_wf3
    ds_read_b64 a[0:1], v245 offset:0
    ds_read_b64 a[2:3], v245 offset:32
    ds_read_b64 a[18:19], v245 offset:4864
    ds_read_b64 a[20:21], v245 offset:4896
    ds_read_b64 a[36:37], v245 offset:9728
    ds_read_b64 a[38:39], v245 offset:9760
    ds_read_b64 a[4:5], v245 offset:64
    ds_read_b64 a[6:7], v245 offset:96
    ds_read_b64 a[22:23], v245 offset:4928
    ds_read_b64 a[24:25], v245 offset:4960
    ds_read_b64 a[40:41], v245 offset:9792
    ds_read_b64 a[42:43], v245 offset:9824
    s_waitcnt lgkmcnt(6)
    s_nop 0
    v_mfma_f32_16x16x32_bf16 v[108:111], a[0:3], v[88:91], 0
    ds_read_b64 a[8:9], v245 offset:128
    ds_read_b64 a[10:11], v245 offset:160
    v_mfma_f32_16x16x32_bf16 v[112:115], a[18:21], v[88:91], 0
    ds_read_b64 a[26:27], v245 offset:4992
    ds_read_b64 a[28:29], v245 offset:5024
    v_mfma_f32_16x16x32_bf16 v[116:119], a[36:39], v[88:91], 0
    ds_read_b64 a[44:45], v245 offset:9856
    ds_read_b64 a[46:47], v245 offset:9888
    s_waitcnt lgkmcnt(6)
    s_nop 0
    v_mfma_f32_16x16x32_bf16 v[108:111], a[4:7], v[92:95], v[108:111]
    ds_read_b64 a[12:13], v245 offset:192
    ds_read_b64 a[14:15], v245 offset:224
    v_mfma_f32_16x16x32_bf16 v[112:115], a[22:25], v[92:95], v[112:115]
    ds_read_b64 a[30:31], v245 offset:5056
    ds_read_b64 a[32:33], v245 offset:5088
    v_mfma_f32_16x16x32_bf16 v[116:119], a[40:43], v[92:95], v[116:119]
    ds_read_b64 a[48:49], v245 offset:9920
    ds_read_b64 a[50:51], v245 offset:9952
    s_waitcnt lgkmcnt(6)
    s_nop 0
    v_mfma_f32_16x16x32_bf16 v[108:111], a[8:11], v[96:99], v[108:111]
    ds_read_b64 a[16:17], v245 offset:256
    ds_read_b64 a[34:35], v245 offset:5120
    v_mfma_f32_16x16x32_bf16 v[112:115], a[26:29], v[96:99], v[112:115]
    ds_read_b64 a[52:53], v245 offset:9984
    ds_read_b64 a[54:55], v245 offset:14592
    v_mfma_f32_16x16x32_bf16 v[116:119], a[44:47], v[96:99], v[116:119]
    ds_read_b64 a[56:57], v245 offset:14624
    ds_read_b64 a[72:73], v245 offset:19456
    s_waitcnt lgkmcnt(6)
    s_nop 0
    v_mfma_f32_16x16x32_bf16 v[108:111], a[12:15], v[100:103], v[108:111]
    ds_read_b64 a[74:75], v245 offset:19488
    ds_read_b64 a[90:91], v245 offset:24320
    v_mfma_f32_16x16x32_bf16 v[112:115], a[30:33], v[100:103], v[112:115]
    ds_read_b64 a[92:93], v245 offset:24352
    ds_read_b64 a[58:59], v245 offset:14656
    v_mfma_f32_16x16x32_bf16 v[116:119], a[48:51], v[100:103], v[116:119]
    ds_read_b64 a[60:61], v245 offset:14688
    ds_read_b64 a[76:77], v245 offset:19520
    s_waitcnt lgkmcnt(3)
    s_nop 0
    v_mfma_f32_16x16x32_bf16 v[120:123], a[54:57], v[88:91], 0
    ds_read_b64 a[78:79], v245 offset:19552
    ds_read_b64 a[94:95], v245 offset:24384
    v_mfma_f32_16x16x32_bf16 v[124:127], a[72:75], v[88:91], 0
    ds_read_b64 a[96:97], v245 offset:24416
    ds_read_b64 a[62:63], v245 offset:14720
    v_mfma_f32_16x16x32_bf16 v[128:131], a[90:93], v[88:91], 0
    ds_read_b64 a[64:65], v245 offset:14752
    ds_read_b64 a[80:81], v245 offset:19584
    v_mfma_f32_16x16x16_bf16 v[108:111], a[16:17], v[104:105], v[108:111]
    ds_read_b64 a[82:83], v245 offset:19616
    ds_read_b64 a[98:99], v245 offset:24448
    v_mfma_f32_16x16x16_bf16 v[112:115], a[34:35], v[104:105], v[112:115]
    ds_read_b64 a[100:101], v245 offset:24480
    ds_read_b64 a[66:67], v245 offset:14784
    v_mfma_f32_16x16x16_bf16 v[116:119], a[52:53], v[104:105], v[116:119]
    ds_read_b64 a[68:69], v245 offset:14816
    ds_read_b64 a[84:85], v245 offset:19648
    s_waitcnt lgkmcnt(9)
    s_nop 0
    v_mfma_f32_16x16x32_bf16 v[120:123], a[58:61], v[92:95], v[120:123]
    ds_read_b64 a[86:87], v245 offset:19680
    ds_read_b64 a[102:103], v245 offset:24512
    v_mfma_f32_16x16x32_bf16 v[124:127], a[76:79], v[92:95], v[124:127]
    ds_read_b64 a[104:105], v245 offset:24544
    ds_read_b64 a[70:71], v245 offset:14848
    v_mfma_f32_16x16x32_bf16 v[128:131], a[94:97], v[92:95], v[128:131]
    ds_read_b64 a[88:89], v245 offset:19712
    ds_read_b64 a[106:107], v245 offset:24576
    s_waitcnt lgkmcnt(9)
    s_nop 0
    v_mfma_f32_16x16x32_bf16 v[120:123], a[62:65], v[96:99], v[120:123]
    ds_read_b64 a[0:1], v245 offset:29184
    ds_read_b64 a[2:3], v245 offset:29216
    v_mfma_f32_16x16x32_bf16 v[124:127], a[80:83], v[96:99], v[124:127]
    ds_read_b64 a[18:19], v245 offset:34048
    ds_read_b64 a[20:21], v245 offset:34080
    v_mfma_f32_16x16x32_bf16 v[128:131], a[98:101], v[96:99], v[128:131]
    ds_read_b64 a[36:37], v245 offset:38912
    ds_read_b64 a[38:39], v245 offset:38944
    s_waitcnt lgkmcnt(9)
    s_nop 0
    v_mfma_f32_16x16x32_bf16 v[120:123], a[66:69], v[100:103], v[120:123]
    ds_read_b64 a[4:5], v245 offset:29248
    ds_read_b64 a[6:7], v245 offset:29280
    v_mfma_f32_16x16x32_bf16 v[124:127], a[84:87], v[100:103], v[124:127]
    ds_read_b64 a[22:23], v245 offset:34112
    ds_read_b64 a[24:25], v245 offset:34144
    v_mfma_f32_16x16x32_bf16 v[128:131], a[102:105], v[100:103], v[128:131]
    ds_read_b64 a[40:41], v245 offset:38976
    ds_read_b64 a[42:43], v245 offset:39008
    s_waitcnt lgkmcnt(6)
    s_nop 0
    v_mfma_f32_16x16x32_bf16 v[132:135], a[0:3], v[88:91], 0
    ds_read_b64 a[8:9], v245 offset:29312
    ds_read_b64 a[10:11], v245 offset:29344
    v_mfma_f32_16x16x32_bf16 v[136:139], a[18:21], v[88:91], 0
    ds_read_b64 a[26:27], v245 offset:34176
    ds_read_b64 a[28:29], v245 offset:34208
    v_mfma_f32_16x16x32_bf16 v[140:143], a[36:39], v[88:91], 0
    ds_read_b64 a[44:45], v245 offset:39040
    ds_read_b64 a[46:47], v245 offset:39072
    v_mfma_f32_16x16x16_bf16 v[120:123], a[70:71], v[104:105], v[120:123]
    ds_read_b64 a[12:13], v245 offset:29376
    ds_read_b64 a[14:15], v245 offset:29408
    v_mfma_f32_16x16x16_bf16 v[124:127], a[88:89], v[104:105], v[124:127]
    ds_read_b64 a[30:31], v245 offset:34240
    ds_read_b64 a[32:33], v245 offset:34272
    v_mfma_f32_16x16x16_bf16 v[128:131], a[106:107], v[104:105], v[128:131]
    ds_read_b64 a[48:49], v245 offset:39104
    ds_read_b64 a[50:51], v245 offset:39136
    s_waitcnt lgkmcnt(12)
    s_nop 0
    v_mfma_f32_16x16x32_bf16 v[132:135], a[4:7], v[92:95], v[132:135]
    ds_read_b64 a[16:17], v245 offset:29440
    ds_read_b64 a[34:35], v245 offset:34304
    v_mfma_f32_16x16x32_bf16 v[136:139], a[22:25], v[92:95], v[136:139]
    ds_read_b64 a[52:53], v245 offset:39168
    v_mfma_f32_16x16x32_bf16 v[140:143], a[40:43], v[92:95], v[140:143]
    s_waitcnt lgkmcnt(9)
    v_mfma_f32_16x16x32_bf16 v[132:135], a[8:11], v[96:99], v[132:135]
    v_mfma_f32_16x16x32_bf16 v[136:139], a[26:29], v[96:99], v[136:139]
    v_mfma_f32_16x16x32_bf16 v[140:143], a[44:47], v[96:99], v[140:143]
    s_waitcnt lgkmcnt(3)
    v_mfma_f32_16x16x32_bf16 v[132:135], a[12:15], v[100:103], v[132:135]
    v_mfma_f32_16x16x32_bf16 v[136:139], a[30:33], v[100:103], v[136:139]
    v_mfma_f32_16x16x32_bf16 v[140:143], a[48:51], v[100:103], v[140:143]
    s_waitcnt lgkmcnt(0)
    s_nop 2
    v_mfma_f32_16x16x16_bf16 v[132:135], a[16:17], v[104:105], v[132:135]
    v_mfma_f32_16x16x16_bf16 v[136:139], a[34:35], v[104:105], v[136:139]
    v_mfma_f32_16x16x16_bf16 v[140:143], a[52:53], v[104:105], v[140:143]
    s_nop 7
    v_mov_b32 v208, v140
    v_mov_b32 v209, v140
    s_nop 1
    v_permlane32_swap_b32 v208, v209
    v_mov_b32 v209, v208
    s_nop 1
    v_permlane16_swap_b32 v208, v209
    v_sub_f32 v108, v108, v208
    v_sub_f32 v109, v109, v208
    v_sub_f32 v110, v110, v208
    v_sub_f32 v111, v111, v208
    v_sub_f32 v112, v112, v208
    v_sub_f32 v113, v113, v208
    v_sub_f32 v114, v114, v208
    v_sub_f32 v115, v115, v208
    v_sub_f32 v116, v116, v208
    v_sub_f32 v117, v117, v208
    v_sub_f32 v118, v118, v208
    v_sub_f32 v119, v119, v208
    v_sub_f32 v120, v120, v208
    v_sub_f32 v121, v121, v208
    v_sub_f32 v122, v122, v208
    v_sub_f32 v123, v123, v208
    v_sub_f32 v124, v124, v208
    v_sub_f32 v125, v125, v208
    v_sub_f32 v126, v126, v208
    v_sub_f32 v127, v127, v208
    v_sub_f32 v128, v128, v208
    v_sub_f32 v129, v129, v208
    v_sub_f32 v130, v130, v208
    v_sub_f32 v131, v131, v208
    v_sub_f32 v132, v132, v208
    v_sub_f32 v133, v133, v208
    v_sub_f32 v134, v134, v208
    v_sub_f32 v135, v135, v208
    v_sub_f32 v136, v136, v208
    v_sub_f32 v137, v137, v208
    v_sub_f32 v138, v138, v208
    v_sub_f32 v139, v139, v208
    v_sub_f32 v140, v140, v208
    v_sub_f32 v141, v141, v208
    v_sub_f32 v142, v142, v208
    v_sub_f32 v143, v143, v208
    v_cvt_pk_bf16_f32 v88, v108, v109
    v_cvt_pk_bf16_f32 v89, v110, v111
    v_cvt_pk_bf16_f32 v90, v112, v113
    v_cvt_pk_bf16_f32 v91, v114, v115
    v_cvt_pk_bf16_f32 v92, v116, v117
    v_cvt_pk_bf16_f32 v93, v118, v119
    v_cvt_pk_bf16_f32 v94, v120, v121
    v_cvt_pk_bf16_f32 v95, v122, v123
    v_cvt_pk_bf16_f32 v96, v124, v125
    v_cvt_pk_bf16_f32 v97, v126, v127
    v_cvt_pk_bf16_f32 v98, v128, v129
    v_cvt_pk_bf16_f32 v99, v130, v131
    v_cvt_pk_bf16_f32 v100, v132, v133
    v_cvt_pk_bf16_f32 v101, v134, v135
    v_cvt_pk_bf16_f32 v102, v136, v137
    v_cvt_pk_bf16_f32 v103, v138, v139
    v_cvt_pk_bf16_f32 v104, v140, v141
    v_cvt_pk_bf16_f32 v105, v142, v143
L_wf3:
    s_mul_i32 s52, s45, 4608
    s_add_u32 s52, s52, s56
    s_nop 0
    s_add_u32 s52, s52, 9533440
    s_add_u32 s53, s52, 4096
    buffer_store_dwordx4 v[88:91], v6, s[12:15], s52 offen offset:0 sc1
    buffer_store_dwordx4 v[92:95], v6, s[12:15], s52 offen offset:1024 sc1
    buffer_store_dwordx4 v[96:99], v6, s[12:15], s52 offen offset:2048 sc1
    buffer_store_dwordx4 v[100:103], v6, s[12:15], s52 offen offset:3072 sc1
    buffer_store_dwordx2 v[104:105], v244, s[12:15], s53 offen sc1
    v_add_u32 v240, 128, v240
    v_add_u32 v241, 128, v241
    v_add_u32 v242, 128, v242
    s_add_u32 s45, s45, 4
    s_cmp_lt_u32 s45, 8
    s_cbranch_scc1 L_wfl
    v_sub_u32 v240, v240, v246
    v_sub_u32 v241, v241, v246
    v_sub_u32 v242, v242, v246
    s_cmp_eq_u32 s45, 8
    s_cbranch_scc1 L_wfl
    s_waitcnt vmcnt(0)
    s_barrier
    s_cmp_lg_u32 s40, 0
    s_cbranch_scc1 L_end
    v_mov_b32 v208, s98
    v_lshlrev_b32_e64 v209, 2, v0
    s_lshl_b32 s52, s2, 8
    s_add_u32 s52, s52, 9748992
    buffer_store_dword v208, v209, s[12:15], s52 offen sc1
    s_endpgm
L_moved:
    s_mov_b32 s75, s57
    s_lshr_b32 s57, s40, 1
    s_and_b32 s57, s57, s50
    s_cbranch_scc0 L_movedb
    s_mul_i32 s57, s48, 9216
    s_add_u32 s57, s57, s75
    s_and_b32 s58, s40, 1
    s_lshl_b32 s59, s58, 9
    s_add_u32 s59, s59, s57
    s_add_u32 s59, s59, 8192
    s_lshl_b32 s58, s58, 8
    s_add_u32 s57, s57, s58
    s_add_u32 s58, s57, 4096
    v_subrev_u32 v250, s47, v1
    v_subrev_u32_e64 v251, s47, v2
    buffer_store_dwordx4 v[146:149], v250, s[12:15], s57 offen offset:0 sc1
    buffer_store_dwordx4 v[150:153], v250, s[12:15], s57 offen offset:2048 sc1
    buffer_store_dwordx4 v[154:157], v250, s[12:15], s58 offen offset:0 sc1
    buffer_store_dwordx4 v[158:161], v250, s[12:15], s58 offen offset:2048 sc1
    v_mov_b32 v104, v162
    v_mov_b32 v105, v163
    s_mov_b32 s57, 0xffff
    s_mov_b64 exec, 0xffff
    v_mov_b32 v106, 0x3f80
    v_bfi_b32 v104, s57, v106, v104
    s_mov_b64 exec, -1
    buffer_store_dwordx2 v[104:105], v251, s[12:15], s59 offen sc1
    s_waitcnt vmcnt(0)
    s_branch L_movedb
L_fallback:
    s_waitcnt vmcnt(0) lgkmcnt(0)
    s_barrier
    s_mov_b32 s51, 1
    s_mov_b32 s25, 0x40000000
    s_mov_b32 s26, 2.0
    s_mov_b32 s27, 2.0
    s_mul_i32 s52, s41, 125
    s_mul_i32 s53, s42, 63
    s_add_u32 s53, s53, s52
    s_mul_i32 s53, s53, 9216
    s_add_u32 s53, s53, s75
    s_add_u32 s16, s12, s53
    s_addc_u32 s17, s13, 0
    s_sub_u32 s54, 63, s42
    s_mul_i32 s18, s54, 9216
    s_mov_b32 s19, 0x20000
    s_mov_b32 s44, s47
    s_cmp_eq_u32 s46, 4
    s_cselect_b32 s45, 15, 16
    v_mov_b32 v208, 0xff800000
    v_mov_b32 v209, 0xff800000
    v_mov_b32 v210, 0xff800000
    v_mov_b32 v211, 0xff800000
L_fb1:
    s_add_u32 m0, s47, 0
    s_nop 0
    buffer_load_dwordx4 v6, s[16:19], s44 offen offset:0  lds
    buffer_load_dwordx4 v6, s[16:19], s44 offen offset:1024  lds
    buffer_load_dwordx4 v6, s[16:19], s44 offen offset:2048  lds
    buffer_load_dwordx4 v6, s[16:19], s44 offen offset:3072  lds
    s_add_u32 m0, s47, 4096
    s_nop 0
    s_nop 0
    buffer_load_dwordx4 v7, s[16:19], s44 offen offset:0  lds
    buffer_load_dwordx4 v7, s[16:19], s44 offen offset:1024  lds
    buffer_load_dwordx4 v7, s[16:19], s44 offen offset:2048  lds
    buffer_load_dwordx4 v7, s[16:19], s44 offen offset:3072  lds
    s_add_u32 m0, s47, 8192
    s_nop 0
    buffer_load_dwordx4 v8, s[16:19], s44 offen offset:0  lds
    s_add_u32 s44, s44, 36864
    s_waitcnt vmcnt(0)
    ds_read_b128 v[128:131], v1 offset:0
    ds_read_b128 v[132:135], v1 offset:256
    ds_read_b128 v[136:139], v1 offset:2048
    ds_read_b128 v[140:143], v1 offset:2304
    ds_read_b128 v[144:147], v1 offset:4096
    ds_read_b128 v[148:151], v1 offset:4352
    ds_read_b128 v[152:155], v1 offset:6144
    ds_read_b128 v[156:159], v1 offset:6400
    ds_read_b64 v[160:161], v2 offset:8192
    ds_read_b64 v[162:163], v2 offset:8704
    s_waitcnt lgkmcnt(0)
    s_nop 0
    v_mfma_f32_16x16x32_bf16 v[16:19], v[128:131], a[144:147], 0
    v_mfma_f32_16x16x32_bf16 v[24:27], v[128:131], a[162:165], 0
    v_mfma_f32_16x16x32_bf16 v[32:35], v[128:131], a[180:183], 0
    v_mfma_f32_16x16x32_bf16 v[40:43], v[128:131], a[198:201], 0
    v_mfma_f32_16x16x32_bf16 v[20:23], v[132:135], a[144:147], 0
    v_mfma_f32_16x16x32_bf16 v[28:31], v[132:135], a[162:165], 0
    v_mfma_f32_16x16x32_bf16 v[36:39], v[132:135], a[180:183], 0
    v_mfma_f32_16x16x32_bf16 v[44:47], v[132:135], a[198:201], 0
    v_mfma_f32_16x16x32_bf16 v[16:19], v[136:139], a[148:151], v[16:19]
    v_mfma_f32_16x16x32_bf16 v[24:27], v[136:139], a[166:169], v[24:27]
    v_mfma_f32_16x16x32_bf16 v[32:35], v[136:139], a[184:187], v[32:35]
    v_mfma_f32_16x16x32_bf16 v[40:43], v[136:139], a[202:205], v[40:43]
    v_mfma_f32_16x16x32_bf16 v[20:23], v[140:143], a[148:151], v[20:23]
    v_mfma_f32_16x16x32_bf16 v[28:31], v[140:143], a[166:169], v[28:31]
    v_mfma_f32_16x16x32_bf16 v[36:39], v[140:143], a[184:187], v[36:39]
    v_mfma_f32_16x16x32_bf16 v[44:47], v[140:143], a[202:205], v[44:47]
    v_mfma_f32_16x16x32_bf16 v[16:19], v[144:147], a[152:155], v[16:19]
    v_mfma_f32_16x16x32_bf16 v[24:27], v[144:147], a[170:173], v[24:27]
    v_mfma_f32_16x16x32_bf16 v[32:35], v[144:147], a[188:191], v[32:35]
    v_mfma_f32_16x16x32_bf16 v[40:43], v[144:147], a[206:209], v[40:43]
    v_mfma_f32_16x16x32_bf16 v[20:23], v[148:151], a[152:155], v[20:23]
    v_mfma_f32_16x16x32_bf16 v[28:31], v[148:151], a[170:173], v[28:31]
    v_mfma_f32_16x16x32_bf16 v[36:39], v[148:151], a[188:191], v[36:39]
    v_mfma_f32_16x16x32_bf16 v[44:47], v[148:151], a[206:209], v[44:47]
    v_mfma_f32_16x16x32_bf16 v[16:19], v[152:155], a[156:159], v[16:19]
    v_mfma_f32_16x16x32_bf16 v[24:27], v[152:155], a[174:177], v[24:27]
    v_mfma_f32_16x16x32_bf16 v[32:35], v[152:155], a[192:195], v[32:35]
    v_mfma_f32_16x16x32_bf16 v[40:43], v[152:155], a[210:213], v[40:43]
    v_mfma_f32_16x16x32_bf16 v[20:23], v[156:159], a[156:159], v[20:23]
    v_mfma_f32_16x16x32_bf16 v[28:31], v[156:159], a[174:177], v[28:31]
    v_mfma_f32_16x16x32_bf16 v[36:39], v[156:159], a[192:195], v[36:39]
    v_mfma_f32_16x16x32_bf16 v[44:47], v[156:159], a[210:213], v[44:47]
    v_mfma_f32_16x16x16_bf16 v[16:19], v[160:161], a[160:161], v[16:19]
    v_mfma_f32_16x16x16_bf16 v[24:27], v[160:161], a[178:179], v[24:27]
    v_mfma_f32_16x16x16_bf16 v[32:35], v[160:161], a[196:197], v[32:35]
    v_mfma_f32_16x16x16_bf16 v[40:43], v[160:161], a[214:215], v[40:43]
    v_mfma_f32_16x16x16_bf16 v[20:23], v[162:163], a[160:161], v[20:23]
    v_mfma_f32_16x16x16_bf16 v[28:31], v[162:163], a[178:179], v[28:31]
    v_mfma_f32_16x16x16_bf16 v[36:39], v[162:163], a[196:197], v[36:39]
    v_mfma_f32_16x16x16_bf16 v[44:47], v[162:163], a[214:215], v[44:47]
    s_nop 7
    s_nop 0
    v_max3_f32 v208, v208, v16, v17
    v_max3_f32 v208, v208, v18, v19
    v_max3_f32 v208, v208, v20, v21
    v_max3_f32 v208, v208, v22, v23
    v_max3_f32 v209, v209, v24, v25
    v_max3_f32 v209, v209, v26, v27
    v_max3_f32 v209, v209, v28, v29
    v_max3_f32 v209, v209, v30, v31
    v_max3_f32 v210, v210, v32, v33
    v_max3_f32 v210, v210, v34, v35
    v_max3_f32 v210, v210, v36, v37
    v_max3_f32 v210, v210, v38, v39
    v_max3_f32 v211, v211, v40, v41
    v_max3_f32 v211, v211, v42, v43
    v_max3_f32 v211, v211, v44, v45
    v_max3_f32 v211, v211, v46, v47
    s_sub_u32 s45, s45, 1
    s_cmp_lg_u32 s45, 0
    s_cbranch_scc1 L_fb1
    v_mov_b32 v212, v208
    v_mov_b32 v213, v209
    v_mov_b32 v214, v210
    v_mov_b32 v215, v211
    v_permlane32_swap_b32 v208, v212
    v_permlane32_swap_b32 v209, v213
    v_permlane32_swap_b32 v210, v214
    v_permlane32_swap_b32 v211, v215
    v_max_f32 v208, v208, v212
    v_max_f32 v209, v209, v213
    v_max_f32 v210, v210, v214
    v_max_f32 v211, v211, v215
    v_mov_b32 v212, v208
    v_mov_b32 v213, v209
    v_mov_b32 v214, v210
    v_mov_b32 v215, v211
    v_permlane16_swap_b32 v208, v212
    v_permlane16_swap_b32 v209, v213
    v_permlane16_swap_b32 v210, v214
    v_permlane16_swap_b32 v211, v215
    v_max_f32 v208, v208, v212
    v_max_f32 v209, v209, v213
    v_max_f32 v210, v210, v214
    v_max_f32 v211, v211, v215
    v_and_b32 v212, 15, v0
    v_lshlrev_b32_e64 v212, 4, v212
    v_add_u32 v212, 147456, v212
    s_lshl_b32 s52, s40, 2
    s_xor_b32 s53, s3, 1
    v_lshl_add_u32 v213, s3, 8, v212
    v_lshl_add_u32 v212, s53, 8, v212
    v_add_u32 v214, s52, v212
    v_add_u32 v215, s52, v213
    ds_write_b32 v214, v208 offset:0
    ds_write_b32 v215, v209 offset:0
    ds_write_b32 v214, v210 offset:512
    ds_write_b32 v215, v211 offset:512
    s_waitcnt lgkmcnt(0)
    s_barrier
    ds_read_b128 v[16:19], v212 offset:0
    ds_read_b128 v[20:23], v213 offset:0
    ds_read_b128 v[24:27], v212 offset:512
    ds_read_b128 v[28:31], v213 offset:512
    s_mov_b32 s44, s47
    s_add_u32 m0, s47, 0
    s_nop 0
    s_nop 0
    buffer_load_dwordx4 v6, s[16:19], s44 offen offset:0  lds
    buffer_load_dwordx4 v6, s[16:19], s44 offen offset:1024  lds
    buffer_load_dwordx4 v6, s[16:19], s44 offen offset:2048  lds
    buffer_load_dwordx4 v6, s[16:19], s44 offen offset:3072  lds
    s_add_u32 m0, s47, 4096
    s_nop 0
    s_nop 0
    buffer_load_dwordx4 v7, s[16:19], s44 offen offset:0  lds
    buffer_load_dwordx4 v7, s[16:19], s44 offen offset:1024  lds
    buffer_load_dwordx4 v7, s[16:19], s44 offen offset:2048  lds
    buffer_load_dwordx4 v7, s[16:19], s44 offen offset:3072  lds
    s_add_u32 m0, s47, 8192
    s_nop 0
    buffer_load_dwordx4 v8, s[16:19], s44 offen offset:0  lds
    s_add_u32 s44, s44, 36864
    s_add_u32 m0, s47, 36864
    s_nop 0
    buffer_load_dwordx4 v6, s[16:19], s44 offen offset:0  lds
    buffer_load_dwordx4 v6, s[16:19], s44 offen offset:1024  lds
    buffer_load_dwordx4 v6, s[16:19], s44 offen offset:2048  lds
    buffer_load_dwordx4 v6, s[16:19], s44 offen offset:3072  lds
    s_add_u32 m0, s47, 40960
    s_nop 0
    s_nop 0
    buffer_load_dwordx4 v7, s[16:19], s44 offen offset:0  lds
    buffer_load_dwordx4 v7, s[16:19], s44 offen offset:1024  lds
    buffer_load_dwordx4 v7, s[16:19], s44 offen offset:2048  lds
    buffer_load_dwordx4 v7, s[16:19], s44 offen offset:3072  lds
    s_add_u32 m0, s47, 45056
    s_nop 0
    buffer_load_dwordx4 v8, s[16:19], s44 offen offset:0  lds
    s_add_u32 s44, s44, 36864
    s_waitcnt lgkmcnt(0)
    v_max_f32_e64 v16, v16, v17
    v_max3_f32 v16, v16, v18, v19
    v_sub_f32 v232, 0, v16
    v_max_f32 v20, v20, v21
    v_max3_f32 v20, v20, v22, v23
    v_sub_f32 v233, 0, v20
    v_max_f32 v24, v24, v25
    v_max3_f32 v24, v24, v26, v27
    v_sub_f32 v234, 0, v24
    v_max_f32 v28, v28, v29
    v_max3_f32 v28, v28, v30, v31
    v_sub_f32_e64 v235, 0, v28
    s_mov_b32 s54, 0xffff
    v_cvt_pk_bf16_f32 v16, v232, v232
    v_accvgpr_read_b32 v17, a160
    v_lshlrev_b32_e64 v232, 16, v16
    v_bfi_b32 v17, s54, v16, v17
    v_cvt_pk_bf16_f32 v20, v233, v233
    v_accvgpr_read_b32 v21, a178
    v_lshlrev_b32_e64 v233, 16, v20
    v_bfi_b32 v21, s54, v20, v21
    v_cvt_pk_bf16_f32 v24, v234, v234
    v_accvgpr_read_b32 v25, a196
    v_lshlrev_b32_e64 v234, 16, v24
    v_bfi_b32 v25, s54, v24, v25
    v_cvt_pk_bf16_f32 v28, v235, v235
    v_accvgpr_read_b32 v29, a214
    v_lshlrev_b32_e64 v235, 16, v28
    v_bfi_b32 v29, s54, v28, v29
    s_mov_b64 exec, 0xffff
    v_accvgpr_write_b32 a160, v17
    v_accvgpr_write_b32 a178, v21
    v_accvgpr_write_b32 a196, v25
    v_accvgpr_write_b32 a214, v29
    s_mov_b64 exec, -1
    s_nop 1
    s_waitcnt vmcnt(0)
    s_xor_b32 s53, s3, 1
    v_add_u32 v100, 92160, v6
    v_lshl_add_u32 v96, s53, 12, v100
    v_lshl_add_u32 v97, s3, 12, v100
    v_add_u32 v100, 104448, v246
    v_lshl_add_u32 v98, s53, 9, v100
    v_lshl_add_u32 v99, s3, 9, v100
    ds_write_b128 v96, a[180:183] offset:8192
    ds_write_b128 v96, a[184:187] offset:9216
    ds_write_b128 v96, a[188:191] offset:10240
    ds_write_b128 v96, a[192:195] offset:11264
    ds_write_b64 v98, a[196:197] offset:1024
    ds_write_b128 v97, a[198:201] offset:8192
    ds_write_b128 v97, a[202:205] offset:9216
    ds_write_b128 v97, a[206:209] offset:10240
    ds_write_b128 v97, a[210:213] offset:11264
    ds_write_b64 v99, a[214:215] offset:1024
    ds_read_b128 v[48:51], v1 offset:0
    ds_read_b128 v[52:55], v1 offset:256
    ds_read_b128 v[56:59], v1 offset:2048
    ds_read_b128 v[60:63], v1 offset:2304
    ds_read_b128 v[64:67], v1 offset:4096
    ds_read_b128 v[68:71], v1 offset:4352
    ds_read_b128 v[72:75], v1 offset:6144
    ds_read_b128 v[76:79], v1 offset:6400
    ds_read_b64 v[120:121], v2 offset:8192
    ds_read_b64 v[122:123], v2 offset:8704
    s_waitcnt lgkmcnt(0)
    s_nop 0
    v_add_u32 v200, 73728, v1
    v_add_u32 v201, 73728, v2
    v_add_u32 v202, 73728, v3
    v_add_u32 v203, 73728, v4
    v_add_u32 v204, 73728, v5
    v_add_u32 v205, 73728, v14
    v_add_u32 v206, 73728, v15
    v_add_u32 v250, s47, v6
    v_add_u32_e64 v251, s47, v246
    s_mov_b32 s45, 0
    s_mov_b32 s24, 36864
    v_mov_b32 v226, -1
    v_mov_b32 v227, -1
    v_mov_b32 v228, -1
    v_mov_b32 v229, -1
    v_mov_b32 v207, s98
    v_mov_b32 v249, 1
    v_lshlrev_b32_e64 v231, 2, v0
    v_add_u32 v231, 163584, v231
    s_add_u32 s52, s98, s74
    v_writelane_b32 v207, s52, 1
    s_branch L_go
L_cend:
.section .rodata,"a"
.p2align 6
.amdhsa_kernel standalone__conformer_family_branchformer__speech_kernel
  .amdhsa_next_free_vgpr 512
  .amdhsa_next_free_sgpr 102
  .amdhsa_accum_offset 256
  .amdhsa_group_segment_fixed_size 0
  .amdhsa_kernarg_size 96
  .amdhsa_user_sgpr_count 2
  .amdhsa_user_sgpr_kernarg_segment_ptr 1
  .amdhsa_system_sgpr_workgroup_id_x 1
.end_amdhsa_kernel
```
